```python
import torch

def _softmax(x, axis=-1):
    return torch.softmax(x, dim=axis)
def _gelu(x):
    return torch.nn.functional.gelu(x, approximate="tanh")
def _silu(x):
    return torch.nn.functional.silu(x)
def _sigmoid(x):
    return torch.sigmoid(x)
def _layernorm(x, axis=-1, eps=1e-5):
    m = x.mean(dim=axis, keepdim=True)
    v = x.var(dim=axis, keepdim=True, unbiased=False)
    return (x - m) / torch.sqrt(v + eps)
def _scatter_add(tgt, idx, src, axis=0):
    return tgt.clone().index_add_(axis, idx, src)
def _segment_sum(src, seg, n):
    out = torch.zeros((n,) + src.shape[1:], dtype=src.dtype)
    return out.index_add_(0, seg, src)
def _pad(x, pw):
    flat = tuple(v for pair in reversed(pw) for v in pair)
    return torch.nn.functional.pad(x, flat)

kernel_name = 'parallel_sum__gqa_block_cached__glu_gated_geglu__decode'

def setup_inputs():

    _w = (lambda a: (lambda t: t.to(torch.bfloat16) if t.is_floating_point() else t)(torch.as_tensor(a)))
    def _A_setup():
        B, Sq, D = 1, 1, 640
        Hq, Hkv, Sk, Dh = 32, 32, 8192, 192
        assert Hq % Hkv == 0, (Hq, Hkv)
        return {
            "x": _w((lambda *s: torch.randn(*s, dtype=torch.bfloat16) * 0.05)(B, Sq, D)),
            "k_cache": _w((lambda *s: torch.randn(*s, dtype=torch.bfloat16) * 1.6)(B, Hkv, Sk, Dh)),
            "v_cache": _w((lambda *s: torch.randn(*s, dtype=torch.bfloat16) * 0.8)(B, Hkv, Sk, Dh)),
            "wq": _w((lambda *s: torch.randn(*s, dtype=torch.bfloat16) * 1.6)(D, Hq * Dh) * (D ** -0.5)),
            "wo": _w((lambda *s: torch.randn(*s, dtype=torch.bfloat16) * 0.8)(Hq * Dh, D) * ((Hq * Dh) ** -0.5)),
        }
    _A_in = _A_setup()

    def _B_setup():
        B, S, Dm, Df = 1, 1, 640, 1536
        return {
            "x": _w((lambda *s: torch.randn(*s, dtype=torch.bfloat16) * 0.05)(B, S, Dm)),
            "w_gate": _w((lambda *s: torch.randn(*s, dtype=torch.bfloat16) * 0.4)(Dm, Df) * (Dm ** -0.5)),
            "w_up": _w((lambda *s: torch.randn(*s, dtype=torch.bfloat16) * 0.4)(Dm, Df) * (Dm ** -0.5)),
            "w_down": _w((lambda *s: torch.randn(*s, dtype=torch.bfloat16) * 0.4)(Df, Dm) * (Df ** -0.5)),
        }
    _B_in = _B_setup()

    return {
        "A_x": _A_in["x"],
        "A_k_cache": _A_in["k_cache"],
        "A_v_cache": _A_in["v_cache"],
        "A_wq": _A_in["wq"],
        "A_wo": _A_in["wo"],
        "B_x": _B_in["x"],
        "B_w_gate": _B_in["w_gate"],
        "B_w_up": _B_in["w_up"],
        "B_w_down": _B_in["w_down"],
    }

def reference(A_x, A_k_cache, A_v_cache, A_wq, A_wo, B_x, B_w_gate, B_w_up, B_w_down):
    def _A_ref(x, k_cache, v_cache, wq, wo):
        B, Sq, D = x.shape
        Hq, Dh = 32, 192
        Hkv = k_cache.shape[1]
        rep = Hq // Hkv
        q = (lambda x, *d: x.permute(*d))((x @ wq).reshape(B, Sq, Hq, Dh), 0, 2, 1, 3)
        k = (lambda x, n, axis: torch.repeat_interleave(x, n, dim=axis))(k_cache, rep, axis=1)
        v = (lambda x, n, axis: torch.repeat_interleave(x, n, dim=axis))(v_cache, rep, axis=1)
        scores = torch.einsum("bhqd,bhkd->bhqk", q, k) * (Dh ** -0.5)
        p = _softmax(scores, axis=-1)
        o = torch.einsum("bhqk,bhkd->bhqd", p, v)
        return (lambda x, *d: x.permute(*d))(o, 0, 2, 1, 3).reshape(B, Sq, Hq * Dh) @ wo

    def _B_ref(x, w_gate, w_up, w_down):
        g = torch.einsum("bsd,df->bsf", x, w_gate)
        u = torch.einsum("bsd,df->bsf", x, w_up)
        h = _gelu(g) * u
        return torch.einsum("bsf,fd->bsd", h, w_down)

    x = A_x
    xn = _layernorm(x, axis=-1)
    return x + _A_ref(xn, A_k_cache, A_v_cache, A_wq, A_wo) + _B_ref(xn, B_w_gate, B_w_up, B_w_down)
```

```asm
; @launch grid=(256,1,1) block=(512,1,1) lds=8800
.amdgcn_target "amdgcn-amd-amdhsa--gfx950"
.text
.globl parallel_sum__gqa_block_cached__glu_gated_geglu__decode_kernel
.p2align 8
.type parallel_sum__gqa_block_cached__glu_gated_geglu__decode_kernel,@function
parallel_sum__gqa_block_cached__glu_gated_geglu__decode_kernel:
    s_load_dwordx2 s[20:21], s[0:1], 0
    s_load_dwordx2 s[16:17], s[0:1], 24
    s_load_dwordx2 s[24:25], s[0:1], 88
    s_load_dwordx2 s[28:29], s[0:1], 8
    s_load_dwordx2 s[32:33], s[0:1], 16
    v_lshrrev_b32 v1, 6, v0
    v_and_b32 v0, 63, v0
    s_cmp_ge_u32 s2, 256
    v_readfirstlane_b32 s3, v1
    s_cbranch_scc1 L_end
    s_and_b32 s4, s2, 7
    s_lshr_b32 s5, s2, 3
    s_lshl_b32 s6, s4, 2
    s_and_b32 s8, s5, 3
    s_add_u32 s6, s6, s8
    s_lshr_b32 s7, s5, 2
    s_mov_b32 s26, 1310720
    s_mov_b32 s27, 0x20000
    s_mov_b32 s55, 0xffff0000
    s_cmp_lt_u32 s3, 4
    s_cbranch_scc1 L_stream
    s_mov_b32 s18, 7864320
    s_mov_b32 s19, 0x20000
    s_movk_i32 s22, 1280
    s_mov_b32 s23, s19
    s_sub_u32 s3, s3, 4
    v_lshrrev_b32 v47, 3, v0
    v_and_b32 v46, 7, v0
    v_lshlrev_b32 v46, 4, v46
    s_cmp_lt_u32 s3, 2
    s_cbranch_scc1 L_q0
    s_waitcnt lgkmcnt(0)
    s_load_dword s87, s[24:25], 0
    s_barrier
    s_branch L_idle
L_q0:
    v_mul_u32_u24 v2, 20, v0
    v_mul_u32_u24 v3, 20, v47
    s_mul_i32 s10, s7, 160
    v_mul_u32_u24 v1, 122880, v47
    v_add_u32 v1, v1, v46
    s_mul_i32 s52, s7, 983040
    s_mul_i32 s12, s6, 384
    s_add_u32 s52, s52, s12
    s_waitcnt lgkmcnt(0)
    buffer_load_dwordx4 v[8:11], v2, s[20:23], 0 offen
    buffer_load_dword v12, v2, s[20:23], 0 offen offset:16
    buffer_load_dwordx4 v[14:17], v3, s[20:23], s10 offen
    buffer_load_dword v18, v3, s[20:23], s10 offen offset:16
    s_load_dword s87, s[24:25], 0
    s_cmp_eq_u32 s3, 1
    s_cbranch_scc1 L_w1
    buffer_load_dwordx4 v[96:99], v1, s[16:19], s52 offen offset:0 nt
    buffer_load_dwordx4 v[100:103], v1, s[16:19], s52 offen offset:128 nt
    buffer_load_dwordx4 v[104:107], v1, s[16:19], s52 offen offset:256 nt
    s_add_u32 s52, s52, 12288
    buffer_load_dwordx4 v[108:111], v1, s[16:19], s52 offen offset:0 nt
    buffer_load_dwordx4 v[112:115], v1, s[16:19], s52 offen offset:128 nt
    buffer_load_dwordx4 v[116:119], v1, s[16:19], s52 offen offset:256 nt
    s_add_u32 s52, s52, 12288
    buffer_load_dwordx4 v[120:123], v1, s[16:19], s52 offen offset:0 nt
    buffer_load_dwordx4 v[124:127], v1, s[16:19], s52 offen offset:128 nt
    buffer_load_dwordx4 v[128:131], v1, s[16:19], s52 offen offset:256 nt
    s_add_u32 s52, s52, 12288
    buffer_load_dwordx4 v[132:135], v1, s[16:19], s52 offen offset:0 nt
    buffer_load_dwordx4 v[136:139], v1, s[16:19], s52 offen offset:128 nt
    buffer_load_dwordx4 v[140:143], v1, s[16:19], s52 offen offset:256 nt
    s_add_u32 s52, s52, 12288
    buffer_load_dwordx4 v[144:147], v1, s[16:19], s52 offen offset:0 nt
    buffer_load_dwordx4 v[148:151], v1, s[16:19], s52 offen offset:128 nt
    buffer_load_dwordx4 v[152:155], v1, s[16:19], s52 offen offset:256 nt
    s_add_u32 s52, s52, 12288
    buffer_load_dwordx4 v[156:159], v1, s[16:19], s52 offen offset:0 nt
    buffer_load_dwordx4 v[160:163], v1, s[16:19], s52 offen offset:128 nt
    buffer_load_dwordx4 v[164:167], v1, s[16:19], s52 offen offset:256 nt
    s_add_u32 s52, s52, 12288
    buffer_load_dwordx4 v[168:171], v1, s[16:19], s52 offen offset:0 nt
    buffer_load_dwordx4 v[172:175], v1, s[16:19], s52 offen offset:128 nt
    buffer_load_dwordx4 v[176:179], v1, s[16:19], s52 offen offset:256 nt
    s_add_u32 s52, s52, 12288
    buffer_load_dwordx4 v[180:183], v1, s[16:19], s52 offen offset:0 nt
    buffer_load_dwordx4 v[184:187], v1, s[16:19], s52 offen offset:128 nt
    buffer_load_dwordx4 v[188:191], v1, s[16:19], s52 offen offset:256 nt
    s_add_u32 s52, s52, 12288
    buffer_load_dwordx4 v[192:195], v1, s[16:19], s52 offen offset:0 nt
    buffer_load_dwordx4 v[196:199], v1, s[16:19], s52 offen offset:128 nt
    buffer_load_dwordx4 v[200:203], v1, s[16:19], s52 offen offset:256 nt
    s_add_u32 s52, s52, 12288
    buffer_load_dwordx4 v[204:207], v1, s[16:19], s52 offen offset:0 nt
    buffer_load_dwordx4 v[208:211], v1, s[16:19], s52 offen offset:128 nt
    buffer_load_dwordx4 v[212:215], v1, s[16:19], s52 offen offset:256 nt
    s_barrier
    s_waitcnt vmcnt(30)
    s_branch L_ln
L_w1:
    s_and_b32 s8, s5, 3
    s_mul_i32 s58, s4, 3
    s_add_u32 s58, s58, s8
    s_cmp_lt_u32 s8, 3
    s_cbranch_scc0 L_w1b
    s_load_dwordx2 s[28:29], s[0:1], 48
    s_mov_b32 s30, 1966080
    s_mov_b32 s31, 0x20000
    s_load_dwordx2 s[32:33], s[0:1], 56
    s_mov_b32 s34, 1966080
    s_mov_b32 s35, 0x20000
    v_mul_u32_u24 v1, 30720, v47
    v_add_u32 v1, v1, v46
    s_mul_i32 s52, s7, 245760
    s_lshl_b32 s12, s58, 7
    s_add_u32 s52, s52, s12
    s_waitcnt lgkmcnt(0)
    buffer_load_dwordx4 v[96:99], v1, s[28:31], s52 offen offset:0 nt
    buffer_load_dwordx4 v[100:103], v1, s[32:35], s52 offen offset:0 nt
    buffer_load_dwordx4 v[104:107], v1, s[28:31], s52 offen offset:3072 nt
    buffer_load_dwordx4 v[108:111], v1, s[32:35], s52 offen offset:3072 nt
    s_add_u32 s52, s52, 6144
    buffer_load_dwordx4 v[112:115], v1, s[28:31], s52 offen offset:0 nt
    buffer_load_dwordx4 v[116:119], v1, s[32:35], s52 offen offset:0 nt
    buffer_load_dwordx4 v[120:123], v1, s[28:31], s52 offen offset:3072 nt
    buffer_load_dwordx4 v[124:127], v1, s[32:35], s52 offen offset:3072 nt
    s_add_u32 s52, s52, 6144
    buffer_load_dwordx4 v[128:131], v1, s[28:31], s52 offen offset:0 nt
    buffer_load_dwordx4 v[132:135], v1, s[32:35], s52 offen offset:0 nt
    buffer_load_dwordx4 v[136:139], v1, s[28:31], s52 offen offset:3072 nt
    buffer_load_dwordx4 v[140:143], v1, s[32:35], s52 offen offset:3072 nt
    s_add_u32 s52, s52, 6144
    buffer_load_dwordx4 v[144:147], v1, s[28:31], s52 offen offset:0 nt
    buffer_load_dwordx4 v[148:151], v1, s[32:35], s52 offen offset:0 nt
    buffer_load_dwordx4 v[152:155], v1, s[28:31], s52 offen offset:3072 nt
    buffer_load_dwordx4 v[156:159], v1, s[32:35], s52 offen offset:3072 nt
    s_add_u32 s52, s52, 6144
    buffer_load_dwordx4 v[160:163], v1, s[28:31], s52 offen offset:0 nt
    buffer_load_dwordx4 v[164:167], v1, s[32:35], s52 offen offset:0 nt
    buffer_load_dwordx4 v[168:171], v1, s[28:31], s52 offen offset:3072 nt
    buffer_load_dwordx4 v[172:175], v1, s[32:35], s52 offen offset:3072 nt
L_w1b:
    s_barrier
    s_waitcnt vmcnt(0)
L_ln:
    v_lshlrev_b32 v68, 16, v8
    v_and_b32 v69, s55, v8
    v_lshlrev_b32 v70, 16, v9
    v_and_b32 v71, s55, v9
    v_lshlrev_b32 v72, 16, v10
    v_and_b32 v73, s55, v10
    v_lshlrev_b32 v74, 16, v11
    v_and_b32 v75, s55, v11
    v_lshlrev_b32 v76, 16, v12
    v_and_b32 v77, s55, v12
    v_add_f32 v78, v68, v69
    v_add_f32 v78, v78, v70
    v_add_f32 v78, v78, v71
    v_add_f32 v78, v78, v72
    v_add_f32 v78, v78, v73
    v_add_f32 v78, v78, v74
    v_add_f32 v78, v78, v75
    v_add_f32 v78, v78, v76
    v_add_f32 v78, v78, v77
    s_nop 1
    v_add_f32_dpp v78, v78, v78 quad_perm:[1,0,3,2] row_mask:0xf bank_mask:0xf
    s_nop 1
    v_add_f32_dpp v78, v78, v78 quad_perm:[2,3,0,1] row_mask:0xf bank_mask:0xf
    s_nop 1
    v_add_f32_dpp v78, v78, v78 row_half_mirror row_mask:0xf bank_mask:0xf
    s_nop 1
    v_add_f32_dpp v78, v78, v78 row_ror:8 row_mask:0xf bank_mask:0xf
    v_mov_b32 v80, v78
    s_nop 1
    v_permlane16_swap_b32 v78, v80
    v_add_f32 v78, v78, v80
    v_mov_b32 v80, v78
    s_nop 1
    v_permlane32_swap_b32 v78, v80
    v_add_f32 v78, v78, v80
    v_mul_f32 v78, 0x3acccccd, v78
    v_sub_f32 v68, v68, v78
    v_sub_f32 v69, v69, v78
    v_sub_f32 v70, v70, v78
    v_sub_f32 v71, v71, v78
    v_sub_f32 v72, v72, v78
    v_sub_f32 v73, v73, v78
    v_sub_f32 v74, v74, v78
    v_sub_f32 v75, v75, v78
    v_sub_f32 v76, v76, v78
    v_sub_f32 v77, v77, v78
    v_mul_f32 v79, v68, v68
    v_fmac_f32 v79, v69, v69
    v_fmac_f32 v79, v70, v70
    v_fmac_f32 v79, v71, v71
    v_fmac_f32 v79, v72, v72
    v_fmac_f32 v79, v73, v73
    v_fmac_f32 v79, v74, v74
    v_fmac_f32 v79, v75, v75
    v_fmac_f32 v79, v76, v76
    v_fmac_f32 v79, v77, v77
    s_nop 1
    v_add_f32_dpp v79, v79, v79 quad_perm:[1,0,3,2] row_mask:0xf bank_mask:0xf
    s_nop 1
    v_add_f32_dpp v79, v79, v79 quad_perm:[2,3,0,1] row_mask:0xf bank_mask:0xf
    s_nop 1
    v_add_f32_dpp v79, v79, v79 row_half_mirror row_mask:0xf bank_mask:0xf
    s_nop 1
    v_add_f32_dpp v79, v79, v79 row_ror:8 row_mask:0xf bank_mask:0xf
    v_mov_b32 v80, v79
    s_nop 1
    v_permlane16_swap_b32 v79, v80
    v_add_f32 v79, v79, v80
    v_mov_b32 v80, v79
    s_nop 1
    v_permlane32_swap_b32 v79, v80
    v_add_f32 v79, v79, v80
    v_mul_f32 v79, 0x3acccccd, v79
    v_cvt_pk_bf16_f32 v79, v79, v79
    v_and_b32 v79, s55, v79
    v_cvt_pk_bf16_f32 v78, v78, v78
    v_and_b32 v78, s55, v78
    v_add_f32 v79, 0x3727c5ac, v79
    v_cvt_pk_bf16_f32 v79, v79, v79
    v_and_b32 v79, s55, v79
    v_sqrt_f32 v79, v79
    s_nop 0
    v_cvt_pk_bf16_f32 v79, v79, v79
    v_and_b32 v79, s55, v79
    v_rcp_f32 v79, v79
    v_lshlrev_b32 v26, 16, v14
    v_and_b32 v27, s55, v14
    v_lshlrev_b32 v28, 16, v15
    v_and_b32 v29, s55, v15
    v_lshlrev_b32 v30, 16, v16
    v_and_b32 v31, s55, v16
    v_lshlrev_b32 v32, 16, v17
    v_and_b32 v33, s55, v17
    v_lshlrev_b32 v34, 16, v18
    v_and_b32 v35, s55, v18
    v_sub_f32 v26, v26, v78
    v_sub_f32 v27, v27, v78
    v_sub_f32 v28, v28, v78
    v_sub_f32 v29, v29, v78
    v_sub_f32 v30, v30, v78
    v_sub_f32 v31, v31, v78
    v_sub_f32 v32, v32, v78
    v_sub_f32 v33, v33, v78
    v_sub_f32 v34, v34, v78
    v_sub_f32 v35, v35, v78
    v_cvt_pk_bf16_f32 v26, v26, v26
    v_cvt_pk_bf16_f32 v27, v27, v27
    v_cvt_pk_bf16_f32 v28, v28, v28
    v_cvt_pk_bf16_f32 v29, v29, v29
    v_cvt_pk_bf16_f32 v30, v30, v30
    v_cvt_pk_bf16_f32 v31, v31, v31
    v_cvt_pk_bf16_f32 v32, v32, v32
    v_cvt_pk_bf16_f32 v33, v33, v33
    v_cvt_pk_bf16_f32 v34, v34, v34
    v_cvt_pk_bf16_f32 v35, v35, v35
    v_and_b32 v26, s55, v26
    v_and_b32 v27, s55, v27
    v_and_b32 v28, s55, v28
    v_and_b32 v29, s55, v29
    v_and_b32 v30, s55, v30
    v_and_b32 v31, s55, v31
    v_and_b32 v32, s55, v32
    v_and_b32 v33, s55, v33
    v_and_b32 v34, s55, v34
    v_and_b32 v35, s55, v35
    v_mul_f32 v26, v26, v79
    v_mul_f32 v27, v27, v79
    v_mul_f32 v28, v28, v79
    v_mul_f32 v29, v29, v79
    v_mul_f32 v30, v30, v79
    v_mul_f32 v31, v31, v79
    v_mul_f32 v32, v32, v79
    v_mul_f32 v33, v33, v79
    v_mul_f32 v34, v34, v79
    v_mul_f32 v35, v35, v79
    v_cvt_pk_bf16_f32 v26, v26, v26
    v_cvt_pk_bf16_f32 v27, v27, v27
    v_cvt_pk_bf16_f32 v28, v28, v28
    v_cvt_pk_bf16_f32 v29, v29, v29
    v_cvt_pk_bf16_f32 v30, v30, v30
    v_cvt_pk_bf16_f32 v31, v31, v31
    v_cvt_pk_bf16_f32 v32, v32, v32
    v_cvt_pk_bf16_f32 v33, v33, v33
    v_cvt_pk_bf16_f32 v34, v34, v34
    v_cvt_pk_bf16_f32 v35, v35, v35
    s_cmp_eq_u32 s3, 1
    s_cbranch_scc1 L_idle
    v_and_b32 v2, 1, v0
    v_lshlrev_b32 v2, 4, v2
    v_mov_b32 v3, 0xffff
    v_lshlrev_b32 v3, v2, v3
    v_bfe_u32 v2, v0, 1, 2
    v_cmp_eq_u32 vcc, 0, v2
    s_nop 1
    v_cndmask_b32 v4, 0, v3, vcc
    v_cmp_eq_u32 vcc, 1, v2
    s_nop 1
    v_cndmask_b32 v5, 0, v3, vcc
    v_cmp_eq_u32 vcc, 2, v2
    s_nop 1
    v_cndmask_b32 v6, 0, v3, vcc
    v_cmp_eq_u32 vcc, 3, v2
    s_nop 1
    v_cndmask_b32 v7, 0, v3, vcc
    v_and_b32 v60, v4, v26
    v_and_b32 v61, v5, v26
    v_and_b32 v62, v6, v26
    v_and_b32 v63, v7, v26
    v_and_b32 v64, v4, v27
    v_and_b32 v65, v5, v27
    v_and_b32 v66, v6, v27
    v_and_b32 v67, v7, v27
    s_waitcnt vmcnt(27)
    v_mfma_f32_16x16x32_bf16 v[48:51], v[60:63], v[96:99], 0
    v_mfma_f32_16x16x32_bf16 v[52:55], v[60:63], v[100:103], 0
    v_mfma_f32_16x16x32_bf16 v[56:59], v[60:63], v[104:107], 0
    v_and_b32 v60, v4, v28
    v_and_b32 v61, v5, v28
    v_and_b32 v62, v6, v28
    v_and_b32 v63, v7, v28
    s_waitcnt vmcnt(24)
    v_mfma_f32_16x16x32_bf16 v[48:51], v[64:67], v[108:111], v[48:51]
    v_mfma_f32_16x16x32_bf16 v[52:55], v[64:67], v[112:115], v[52:55]
    v_mfma_f32_16x16x32_bf16 v[56:59], v[64:67], v[116:119], v[56:59]
    v_and_b32 v64, v4, v29
    v_and_b32 v65, v5, v29
    v_and_b32 v66, v6, v29
    v_and_b32 v67, v7, v29
    s_waitcnt vmcnt(21)
    v_mfma_f32_16x16x32_bf16 v[48:51], v[60:63], v[120:123], v[48:51]
    v_mfma_f32_16x16x32_bf16 v[52:55], v[60:63], v[124:127], v[52:55]
    v_mfma_f32_16x16x32_bf16 v[56:59], v[60:63], v[128:131], v[56:59]
    v_and_b32 v60, v4, v30
    v_and_b32 v61, v5, v30
    v_and_b32 v62, v6, v30
    v_and_b32 v63, v7, v30
    s_waitcnt vmcnt(18)
    v_mfma_f32_16x16x32_bf16 v[48:51], v[64:67], v[132:135], v[48:51]
    v_mfma_f32_16x16x32_bf16 v[52:55], v[64:67], v[136:139], v[52:55]
    v_mfma_f32_16x16x32_bf16 v[56:59], v[64:67], v[140:143], v[56:59]
    v_and_b32 v64, v4, v31
    v_and_b32 v65, v5, v31
    v_and_b32 v66, v6, v31
    v_and_b32 v67, v7, v31
    s_waitcnt vmcnt(15)
    v_mfma_f32_16x16x32_bf16 v[48:51], v[60:63], v[144:147], v[48:51]
    v_mfma_f32_16x16x32_bf16 v[52:55], v[60:63], v[148:151], v[52:55]
    v_mfma_f32_16x16x32_bf16 v[56:59], v[60:63], v[152:155], v[56:59]
    v_and_b32 v60, v4, v32
    v_and_b32 v61, v5, v32
    v_and_b32 v62, v6, v32
    v_and_b32 v63, v7, v32
    s_waitcnt vmcnt(12)
    v_mfma_f32_16x16x32_bf16 v[48:51], v[64:67], v[156:159], v[48:51]
    v_mfma_f32_16x16x32_bf16 v[52:55], v[64:67], v[160:163], v[52:55]
    v_mfma_f32_16x16x32_bf16 v[56:59], v[64:67], v[164:167], v[56:59]
    v_and_b32 v64, v4, v33
    v_and_b32 v65, v5, v33
    v_and_b32 v66, v6, v33
    v_and_b32 v67, v7, v33
    s_waitcnt vmcnt(9)
    v_mfma_f32_16x16x32_bf16 v[48:51], v[60:63], v[168:171], v[48:51]
    v_mfma_f32_16x16x32_bf16 v[52:55], v[60:63], v[172:175], v[52:55]
    v_mfma_f32_16x16x32_bf16 v[56:59], v[60:63], v[176:179], v[56:59]
    v_and_b32 v60, v4, v34
    v_and_b32 v61, v5, v34
    v_and_b32 v62, v6, v34
    v_and_b32 v63, v7, v34
    s_waitcnt vmcnt(6)
    v_mfma_f32_16x16x32_bf16 v[48:51], v[64:67], v[180:183], v[48:51]
    v_mfma_f32_16x16x32_bf16 v[52:55], v[64:67], v[184:187], v[52:55]
    v_mfma_f32_16x16x32_bf16 v[56:59], v[64:67], v[188:191], v[56:59]
    v_and_b32 v64, v4, v35
    v_and_b32 v65, v5, v35
    v_and_b32 v66, v6, v35
    v_and_b32 v67, v7, v35
    s_waitcnt vmcnt(3)
    v_mfma_f32_16x16x32_bf16 v[48:51], v[60:63], v[192:195], v[48:51]
    v_mfma_f32_16x16x32_bf16 v[52:55], v[60:63], v[196:199], v[52:55]
    v_mfma_f32_16x16x32_bf16 v[56:59], v[60:63], v[200:203], v[56:59]
    s_waitcnt vmcnt(0)
    v_mfma_f32_16x16x32_bf16 v[48:51], v[64:67], v[204:207], v[48:51]
    v_mfma_f32_16x16x32_bf16 v[52:55], v[64:67], v[208:211], v[52:55]
    v_mfma_f32_16x16x32_bf16 v[56:59], v[64:67], v[212:215], v[56:59]
    v_mul_u32_u24 v44, 48, v46
    v_lshl_add_u32 v44, v47, 5, v44
    s_mul_i32 s13, s6, 8192
    s_add_u32 s13, s13, 589824
    s_mul_i32 s12, s7, 1024
    s_add_u32 s12, s12, s13
    v_mul_u32_u24 v3, 64, v46
    v_lshl_add_u32 v3, v47, 5, v3
    s_waitcnt lgkmcnt(0)
    s_add_u32 s87, s87, 0x07050301
    s_and_b32 s88, s87, 0xff
    s_bfe_u32 s89, s87, 0x80008
    s_bfe_u32 s90, s87, 0x80010
    s_lshr_b32 s91, s87, 24
    s_movk_i32 s92, 0xff
    s_getreg_b32 s93, hwreg(HW_REG_XCC_ID, 0, 4)
    s_lshl_b32 s93, s93, 12
    s_xor_b32 s93, s93, s87
    v_mov_b32 v71, s93
    v_mov_b32 v75, s93
    v_mov_b32 v79, s93
    v_mov_b32 v83, s93
    v_mov_b32 v84, v48
    v_mov_b32 v85, v49
    v_mov_b32 v86, v50
    v_mov_b32 v87, v51
    v_mov_b32 v88, v52
    v_mov_b32 v89, v53
    v_mov_b32 v90, v54
    v_mov_b32 v91, v55
    v_mov_b32 v92, v56
    v_mov_b32 v93, v57
    v_mov_b32 v94, v58
    v_mov_b32 v95, v59
    v_permlane32_swap_b32 v48, v84
    v_permlane32_swap_b32 v49, v85
    v_permlane32_swap_b32 v50, v86
    v_permlane32_swap_b32 v51, v87
    v_permlane32_swap_b32 v52, v88
    v_permlane32_swap_b32 v53, v89
    v_permlane32_swap_b32 v54, v90
    v_permlane32_swap_b32 v55, v91
    v_permlane32_swap_b32 v56, v92
    v_permlane32_swap_b32 v57, v93
    v_permlane32_swap_b32 v58, v94
    v_permlane32_swap_b32 v59, v95
    v_add_f32_dpp v68, v84, v48 row_ror:8 row_mask:0xf bank_mask:0xf
    v_add_f32_dpp v72, v85, v49 row_ror:8 row_mask:0xf bank_mask:0xf
    v_add_f32_dpp v76, v86, v50 row_ror:8 row_mask:0xf bank_mask:0xf
    v_add_f32_dpp v80, v87, v51 row_ror:8 row_mask:0xf bank_mask:0xf
    v_add_f32_dpp v69, v88, v52 row_ror:8 row_mask:0xf bank_mask:0xf
    v_add_f32_dpp v73, v89, v53 row_ror:8 row_mask:0xf bank_mask:0xf
    v_add_f32_dpp v77, v90, v54 row_ror:8 row_mask:0xf bank_mask:0xf
    v_add_f32_dpp v81, v91, v55 row_ror:8 row_mask:0xf bank_mask:0xf
    v_add_f32_dpp v70, v92, v56 row_ror:8 row_mask:0xf bank_mask:0xf
    v_add_f32_dpp v74, v93, v57 row_ror:8 row_mask:0xf bank_mask:0xf
    v_add_f32_dpp v78, v94, v58 row_ror:8 row_mask:0xf bank_mask:0xf
    v_add_f32_dpp v82, v95, v59 row_ror:8 row_mask:0xf bank_mask:0xf
    v_and_b32 v2, 16, v0
    v_lshl_add_u32 v2, v46, 1, v2
    s_mov_b64 exec, 0x00ff00ff
    buffer_store_dwordx4 v[68:71], v2, s[24:27], s12 offen offset:0
    buffer_store_dwordx4 v[72:75], v2, s[24:27], s12 offen offset:256
    buffer_store_dwordx4 v[76:79], v2, s[24:27], s12 offen offset:512
    buffer_store_dwordx4 v[80:83], v2, s[24:27], s12 offen offset:768
    s_mov_b64 exec, -1
    s_barrier
    s_mov_b32 s61, 4194303
    s_mov_b32 s8, s13
    s_mov_b32 s9, s93
L_qchk:
    s_cmp_eq_u32 s61, 4194300
    s_cbranch_scc0 L_qnb
    s_add_u32 s12, s12, 262144
    v_mov_b32 v71, s87
    v_mov_b32 v75, s87
    v_mov_b32 v79, s87
    v_mov_b32 v83, s87
    s_mov_b64 exec, 0x00ff00ff
    buffer_store_dwordx4 v[68:71], v2, s[24:27], s12 offen offset:0 sc1
    buffer_store_dwordx4 v[72:75], v2, s[24:27], s12 offen offset:256 sc1
    buffer_store_dwordx4 v[76:79], v2, s[24:27], s12 offen offset:512 sc1
    buffer_store_dwordx4 v[80:83], v2, s[24:27], s12 offen offset:768 sc1
    s_mov_b64 exec, -1
L_qnb:
    s_and_b32 s8, s61, 3
    s_cselect_b32 s9, s93, s87
    s_cselect_b32 s8, 0, 262144
    s_add_u32 s8, s8, s13
    buffer_load_dwordx4 v[96:99], v3, s[24:27], s8 offen offset:0 sc1
    buffer_load_dwordx4 v[100:103], v3, s[24:27], s8 offen offset:256 sc1
    buffer_load_dwordx4 v[104:107], v3, s[24:27], s8 offen offset:512 sc1
    buffer_load_dwordx4 v[108:111], v3, s[24:27], s8 offen offset:768 sc1
    buffer_load_dwordx4 v[112:115], v3, s[24:27], s8 offen offset:16 sc1
    buffer_load_dwordx4 v[116:119], v3, s[24:27], s8 offen offset:272 sc1
    buffer_load_dwordx4 v[120:123], v3, s[24:27], s8 offen offset:528 sc1
    buffer_load_dwordx4 v[124:127], v3, s[24:27], s8 offen offset:784 sc1
    s_sub_u32 s61, s61, 1
    s_waitcnt vmcnt(0)
    s_cbranch_scc1 L_qok
    v_xor_b32 v99, s9, v99
    v_xor_b32 v103, s9, v103
    v_xor_b32 v107, s9, v107
    v_xor_b32 v111, s9, v111
    v_xor_b32 v115, s9, v115
    v_xor_b32 v119, s9, v119
    v_xor_b32 v123, s9, v123
    v_xor_b32 v127, s9, v127
    v_or3_b32 v99, v99, v103, v107
    v_or3_b32 v111, v111, v115, v119
    v_or3_b32 v99, v99, v123, v127
    v_or_b32 v99, v99, v111
    v_cmp_ne_u32 vcc, 0, v99
    s_cbranch_vccnz L_qchk
L_qok:
    v_add_f32_dpp v96, v96, v96 quad_perm:[1,0,3,2] row_mask:0xf bank_mask:0xf
    v_add_f32_dpp v97, v97, v97 quad_perm:[1,0,3,2] row_mask:0xf bank_mask:0xf
    v_add_f32_dpp v98, v98, v98 quad_perm:[1,0,3,2] row_mask:0xf bank_mask:0xf
    v_add_f32_dpp v100, v100, v100 quad_perm:[1,0,3,2] row_mask:0xf bank_mask:0xf
    v_add_f32_dpp v101, v101, v101 quad_perm:[1,0,3,2] row_mask:0xf bank_mask:0xf
    v_add_f32_dpp v102, v102, v102 quad_perm:[1,0,3,2] row_mask:0xf bank_mask:0xf
    v_add_f32_dpp v104, v104, v104 quad_perm:[1,0,3,2] row_mask:0xf bank_mask:0xf
    v_add_f32_dpp v105, v105, v105 quad_perm:[1,0,3,2] row_mask:0xf bank_mask:0xf
    v_add_f32_dpp v106, v106, v106 quad_perm:[1,0,3,2] row_mask:0xf bank_mask:0xf
    v_add_f32_dpp v108, v108, v108 quad_perm:[1,0,3,2] row_mask:0xf bank_mask:0xf
    v_add_f32_dpp v109, v109, v109 quad_perm:[1,0,3,2] row_mask:0xf bank_mask:0xf
    v_add_f32_dpp v110, v110, v110 quad_perm:[1,0,3,2] row_mask:0xf bank_mask:0xf
    v_add_f32_dpp v112, v112, v112 quad_perm:[1,0,3,2] row_mask:0xf bank_mask:0xf
    v_add_f32_dpp v113, v113, v113 quad_perm:[1,0,3,2] row_mask:0xf bank_mask:0xf
    v_add_f32_dpp v114, v114, v114 quad_perm:[1,0,3,2] row_mask:0xf bank_mask:0xf
    v_add_f32_dpp v116, v116, v116 quad_perm:[1,0,3,2] row_mask:0xf bank_mask:0xf
    v_add_f32_dpp v117, v117, v117 quad_perm:[1,0,3,2] row_mask:0xf bank_mask:0xf
    v_add_f32_dpp v118, v118, v118 quad_perm:[1,0,3,2] row_mask:0xf bank_mask:0xf
    v_add_f32_dpp v120, v120, v120 quad_perm:[1,0,3,2] row_mask:0xf bank_mask:0xf
    v_add_f32_dpp v121, v121, v121 quad_perm:[1,0,3,2] row_mask:0xf bank_mask:0xf
    v_add_f32_dpp v122, v122, v122 quad_perm:[1,0,3,2] row_mask:0xf bank_mask:0xf
    v_add_f32_dpp v124, v124, v124 quad_perm:[1,0,3,2] row_mask:0xf bank_mask:0xf
    v_add_f32_dpp v125, v125, v125 quad_perm:[1,0,3,2] row_mask:0xf bank_mask:0xf
    v_add_f32_dpp v126, v126, v126 quad_perm:[1,0,3,2] row_mask:0xf bank_mask:0xf
    v_add_f32_dpp v96, v96, v96 quad_perm:[2,3,0,1] row_mask:0xf bank_mask:0xf
    v_add_f32_dpp v97, v97, v97 quad_perm:[2,3,0,1] row_mask:0xf bank_mask:0xf
    v_add_f32_dpp v98, v98, v98 quad_perm:[2,3,0,1] row_mask:0xf bank_mask:0xf
    v_add_f32_dpp v100, v100, v100 quad_perm:[2,3,0,1] row_mask:0xf bank_mask:0xf
    v_add_f32_dpp v101, v101, v101 quad_perm:[2,3,0,1] row_mask:0xf bank_mask:0xf
    v_add_f32_dpp v102, v102, v102 quad_perm:[2,3,0,1] row_mask:0xf bank_mask:0xf
    v_add_f32_dpp v104, v104, v104 quad_perm:[2,3,0,1] row_mask:0xf bank_mask:0xf
    v_add_f32_dpp v105, v105, v105 quad_perm:[2,3,0,1] row_mask:0xf bank_mask:0xf
    v_add_f32_dpp v106, v106, v106 quad_perm:[2,3,0,1] row_mask:0xf bank_mask:0xf
    v_add_f32_dpp v108, v108, v108 quad_perm:[2,3,0,1] row_mask:0xf bank_mask:0xf
    v_add_f32_dpp v109, v109, v109 quad_perm:[2,3,0,1] row_mask:0xf bank_mask:0xf
    v_add_f32_dpp v110, v110, v110 quad_perm:[2,3,0,1] row_mask:0xf bank_mask:0xf
    v_add_f32_dpp v112, v112, v112 quad_perm:[2,3,0,1] row_mask:0xf bank_mask:0xf
    v_add_f32_dpp v113, v113, v113 quad_perm:[2,3,0,1] row_mask:0xf bank_mask:0xf
    v_add_f32_dpp v114, v114, v114 quad_perm:[2,3,0,1] row_mask:0xf bank_mask:0xf
    v_add_f32_dpp v116, v116, v116 quad_perm:[2,3,0,1] row_mask:0xf bank_mask:0xf
    v_add_f32_dpp v117, v117, v117 quad_perm:[2,3,0,1] row_mask:0xf bank_mask:0xf
    v_add_f32_dpp v118, v118, v118 quad_perm:[2,3,0,1] row_mask:0xf bank_mask:0xf
    v_add_f32_dpp v120, v120, v120 quad_perm:[2,3,0,1] row_mask:0xf bank_mask:0xf
    v_add_f32_dpp v121, v121, v121 quad_perm:[2,3,0,1] row_mask:0xf bank_mask:0xf
    v_add_f32_dpp v122, v122, v122 quad_perm:[2,3,0,1] row_mask:0xf bank_mask:0xf
    v_add_f32_dpp v124, v124, v124 quad_perm:[2,3,0,1] row_mask:0xf bank_mask:0xf
    v_add_f32_dpp v125, v125, v125 quad_perm:[2,3,0,1] row_mask:0xf bank_mask:0xf
    v_add_f32_dpp v126, v126, v126 quad_perm:[2,3,0,1] row_mask:0xf bank_mask:0xf
    v_add_f32_dpp v96, v96, v96 row_half_mirror row_mask:0xf bank_mask:0xf
    v_add_f32_dpp v97, v97, v97 row_half_mirror row_mask:0xf bank_mask:0xf
    v_add_f32_dpp v98, v98, v98 row_half_mirror row_mask:0xf bank_mask:0xf
    v_add_f32_dpp v100, v100, v100 row_half_mirror row_mask:0xf bank_mask:0xf
    v_add_f32_dpp v101, v101, v101 row_half_mirror row_mask:0xf bank_mask:0xf
    v_add_f32_dpp v102, v102, v102 row_half_mirror row_mask:0xf bank_mask:0xf
    v_add_f32_dpp v104, v104, v104 row_half_mirror row_mask:0xf bank_mask:0xf
    v_add_f32_dpp v105, v105, v105 row_half_mirror row_mask:0xf bank_mask:0xf
    v_add_f32_dpp v106, v106, v106 row_half_mirror row_mask:0xf bank_mask:0xf
    v_add_f32_dpp v108, v108, v108 row_half_mirror row_mask:0xf bank_mask:0xf
    v_add_f32_dpp v109, v109, v109 row_half_mirror row_mask:0xf bank_mask:0xf
    v_add_f32_dpp v110, v110, v110 row_half_mirror row_mask:0xf bank_mask:0xf
    v_add_f32_dpp v112, v112, v112 row_half_mirror row_mask:0xf bank_mask:0xf
    v_add_f32_dpp v113, v113, v113 row_half_mirror row_mask:0xf bank_mask:0xf
    v_add_f32_dpp v114, v114, v114 row_half_mirror row_mask:0xf bank_mask:0xf
    v_add_f32_dpp v116, v116, v116 row_half_mirror row_mask:0xf bank_mask:0xf
    v_add_f32_dpp v117, v117, v117 row_half_mirror row_mask:0xf bank_mask:0xf
    v_add_f32_dpp v118, v118, v118 row_half_mirror row_mask:0xf bank_mask:0xf
    v_add_f32_dpp v120, v120, v120 row_half_mirror row_mask:0xf bank_mask:0xf
    v_add_f32_dpp v121, v121, v121 row_half_mirror row_mask:0xf bank_mask:0xf
    v_add_f32_dpp v122, v122, v122 row_half_mirror row_mask:0xf bank_mask:0xf
    v_add_f32_dpp v124, v124, v124 row_half_mirror row_mask:0xf bank_mask:0xf
    v_add_f32_dpp v125, v125, v125 row_half_mirror row_mask:0xf bank_mask:0xf
    v_add_f32_dpp v126, v126, v126 row_half_mirror row_mask:0xf bank_mask:0xf
    v_cvt_pk_bf16_f32 v68, v96, v100
    v_cvt_pk_bf16_f32 v69, v104, v108
    v_cvt_pk_bf16_f32 v70, v112, v116
    v_cvt_pk_bf16_f32 v71, v120, v124
    v_cvt_pk_bf16_f32 v72, v97, v101
    v_cvt_pk_bf16_f32 v73, v105, v109
    v_cvt_pk_bf16_f32 v74, v113, v117
    v_cvt_pk_bf16_f32 v75, v121, v125
    v_cvt_pk_bf16_f32 v76, v98, v102
    v_cvt_pk_bf16_f32 v77, v106, v110
    v_cvt_pk_bf16_f32 v78, v114, v118
    v_cvt_pk_bf16_f32 v79, v122, v126
    v_lshlrev_b32 v2, 4, v47
    ds_write_b128 v2, v[68:71] offset:6144
    ds_write_b128 v2, v[72:75] offset:6272
    ds_write_b128 v2, v[76:79] offset:6400
    s_branch L_b1
L_idle:
    v_and_b32 v2, 1, v0
    v_lshlrev_b32 v2, 4, v2
    v_mov_b32 v3, 0xffff
    v_lshlrev_b32 v3, v2, v3
    v_bfe_u32 v2, v0, 1, 2
    v_cmp_eq_u32 vcc, 0, v2
    s_nop 1
    v_cndmask_b32 v4, 0, v3, vcc
    v_cmp_eq_u32 vcc, 1, v2
    s_nop 1
    v_cndmask_b32 v5, 0, v3, vcc
    v_cmp_eq_u32 vcc, 2, v2
    s_nop 1
    v_cndmask_b32 v6, 0, v3, vcc
    v_cmp_eq_u32 vcc, 3, v2
    s_nop 1
    v_cndmask_b32 v7, 0, v3, vcc
    v_mul_u32_u24 v44, 48, v46
    v_lshl_add_u32 v44, v47, 5, v44
    s_waitcnt lgkmcnt(0)
    s_add_u32 s87, s87, 0x07050301
    s_and_b32 s88, s87, 0xff
    s_bfe_u32 s89, s87, 0x80008
    s_bfe_u32 s90, s87, 0x80010
    s_lshr_b32 s91, s87, 24
    s_movk_i32 s92, 0xff
    s_getreg_b32 s93, hwreg(HW_REG_XCC_ID, 0, 4)
    s_lshl_b32 s93, s93, 12
    s_xor_b32 s93, s93, s87
    s_barrier
    s_cmp_eq_u32 s3, 2
    s_cbranch_scc0 L_b1
    v_and_b32 v68, 3, v0
    v_lshlrev_b32 v68, 2, v68
    v_add_u32 v68, 8704, v68
    v_mov_b32 v70, 48
    v_mov_b32 v71, 1
    ds_write2_b32 v68, v70, v71 offset0:0 offset1:4
    v_lshrrev_b32 v68, 2, v46
    v_mov_b32 v72, -1
    ds_write_b32 v68, v72 offset:8736
    v_mov_b32 v73, 0
    ds_write_b32 v73, v73 offset:8784
L_b1:
    s_waitcnt lgkmcnt(0)
    s_barrier
    s_and_b32 s8, s5, 3
    s_mul_i32 s58, s4, 3
    s_add_u32 s58, s58, s8
    s_cmp_lt_u32 s8, 3
    s_cselect_b32 s8, s3, 0
    s_cmp_eq_u32 s8, 1
    s_cbranch_scc0 L_noffn
    v_mov_b32 v3, 0
L_fw:
    ds_read_b32 v2, v3 offset:8704
    s_waitcnt lgkmcnt(0)
    v_readfirstlane_b32 s9, v2
    s_cmp_lt_u32 s9, 60
    s_cbranch_scc1 L_fw
    s_waitcnt vmcnt(0)
    v_and_b32 v60, v4, v26
    v_and_b32 v61, v5, v26
    v_and_b32 v62, v6, v26
    v_and_b32 v63, v7, v26
    s_nop 1
    v_mfma_f32_16x16x32_bf16 v[48:51], v[60:63], v[96:99], 0
    v_mfma_f32_16x16x32_bf16 v[52:55], v[60:63], v[100:103], 0
    v_and_b32 v64, v4, v27
    v_and_b32 v65, v5, v27
    v_and_b32 v66, v6, v27
    v_and_b32 v67, v7, v27
    s_nop 1
    v_mfma_f32_16x16x32_bf16 v[48:51], v[64:67], v[104:107], v[48:51]
    v_mfma_f32_16x16x32_bf16 v[52:55], v[64:67], v[108:111], v[52:55]
    v_and_b32 v60, v4, v28
    v_and_b32 v61, v5, v28
    v_and_b32 v62, v6, v28
    v_and_b32 v63, v7, v28
    s_nop 1
    v_mfma_f32_16x16x32_bf16 v[48:51], v[60:63], v[112:115], v[48:51]
    v_mfma_f32_16x16x32_bf16 v[52:55], v[60:63], v[116:119], v[52:55]
    v_and_b32 v64, v4, v29
    v_and_b32 v65, v5, v29
    v_and_b32 v66, v6, v29
    v_and_b32 v67, v7, v29
    s_nop 1
    v_mfma_f32_16x16x32_bf16 v[48:51], v[64:67], v[120:123], v[48:51]
    v_mfma_f32_16x16x32_bf16 v[52:55], v[64:67], v[124:127], v[52:55]
    v_and_b32 v60, v4, v30
    v_and_b32 v61, v5, v30
    v_and_b32 v62, v6, v30
    v_and_b32 v63, v7, v30
    s_nop 1
    v_mfma_f32_16x16x32_bf16 v[48:51], v[60:63], v[128:131], v[48:51]
    v_mfma_f32_16x16x32_bf16 v[52:55], v[60:63], v[132:135], v[52:55]
    v_and_b32 v64, v4, v31
    v_and_b32 v65, v5, v31
    v_and_b32 v66, v6, v31
    v_and_b32 v67, v7, v31
    s_nop 1
    v_mfma_f32_16x16x32_bf16 v[48:51], v[64:67], v[136:139], v[48:51]
    v_mfma_f32_16x16x32_bf16 v[52:55], v[64:67], v[140:143], v[52:55]
    v_and_b32 v60, v4, v32
    v_and_b32 v61, v5, v32
    v_and_b32 v62, v6, v32
    v_and_b32 v63, v7, v32
    s_nop 1
    v_mfma_f32_16x16x32_bf16 v[48:51], v[60:63], v[144:147], v[48:51]
    v_mfma_f32_16x16x32_bf16 v[52:55], v[60:63], v[148:151], v[52:55]
    v_and_b32 v64, v4, v33
    v_and_b32 v65, v5, v33
    v_and_b32 v66, v6, v33
    v_and_b32 v67, v7, v33
    s_nop 1
    v_mfma_f32_16x16x32_bf16 v[48:51], v[64:67], v[152:155], v[48:51]
    v_mfma_f32_16x16x32_bf16 v[52:55], v[64:67], v[156:159], v[52:55]
    v_and_b32 v60, v4, v34
    v_and_b32 v61, v5, v34
    v_and_b32 v62, v6, v34
    v_and_b32 v63, v7, v34
    s_nop 1
    v_mfma_f32_16x16x32_bf16 v[48:51], v[60:63], v[160:163], v[48:51]
    v_mfma_f32_16x16x32_bf16 v[52:55], v[60:63], v[164:167], v[52:55]
    v_and_b32 v64, v4, v35
    v_and_b32 v65, v5, v35
    v_and_b32 v66, v6, v35
    v_and_b32 v67, v7, v35
    s_nop 1
    v_mfma_f32_16x16x32_bf16 v[48:51], v[64:67], v[168:171], v[48:51]
    v_mfma_f32_16x16x32_bf16 v[52:55], v[64:67], v[172:175], v[52:55]
    v_mov_b32 v3, 0
    ds_read_b32 v8, v3 offset:8784
    s_nop 4
    v_mov_b32 v84, v48
    v_mov_b32 v85, v49
    v_mov_b32 v86, v50
    v_mov_b32 v87, v51
    v_mov_b32 v88, v52
    v_mov_b32 v89, v53
    v_mov_b32 v90, v54
    v_mov_b32 v91, v55
    v_permlane32_swap_b32 v48, v84
    v_permlane32_swap_b32 v49, v85
    v_permlane32_swap_b32 v50, v86
    v_permlane32_swap_b32 v51, v87
    v_permlane32_swap_b32 v52, v88
    v_permlane32_swap_b32 v53, v89
    v_permlane32_swap_b32 v54, v90
    v_permlane32_swap_b32 v55, v91
    v_add_f32_dpp v68, v84, v48 row_ror:8 row_mask:0xf bank_mask:0xf
    v_add_f32_dpp v69, v85, v49 row_ror:8 row_mask:0xf bank_mask:0xf
    v_add_f32_dpp v70, v86, v50 row_ror:8 row_mask:0xf bank_mask:0xf
    v_add_f32_dpp v71, v87, v51 row_ror:8 row_mask:0xf bank_mask:0xf
    v_add_f32_dpp v72, v88, v52 row_ror:8 row_mask:0xf bank_mask:0xf
    v_add_f32_dpp v73, v89, v53 row_ror:8 row_mask:0xf bank_mask:0xf
    v_add_f32_dpp v74, v90, v54 row_ror:8 row_mask:0xf bank_mask:0xf
    v_add_f32_dpp v75, v91, v55 row_ror:8 row_mask:0xf bank_mask:0xf
    v_and_b32 v2, 16, v0
    v_lshl_add_u32 v2, v46, 1, v2
    s_waitcnt lgkmcnt(0)
    v_readfirstlane_b32 s9, v8
    v_mov_b32 v3, 0xff
    v_bfi_b32 v68, v3, s88, v68
    v_bfi_b32 v69, v3, s89, v69
    v_bfi_b32 v70, v3, s90, v70
    v_bfi_b32 v71, v3, s91, v71
    v_bfi_b32 v72, v3, s88, v72
    v_bfi_b32 v73, v3, s89, v73
    v_bfi_b32 v74, v3, s90, v74
    v_bfi_b32 v75, v3, s91, v75
    s_lshl_b32 s8, s58, 3
    s_add_u32 s8, s8, s7
    s_lshl_b32 s8, s8, 9
    s_add_u32 s8, s8, 204800
    s_mov_b64 exec, 0x00ff00ff
    buffer_store_dwordx4 v[68:71], v2, s[24:27], s8 offen
    buffer_store_dwordx4 v[72:75], v2, s[24:27], s8 offen offset:256
    s_add_u32 s8, s8, 917504
    s_cmp_eq_u32 s9, 1
    s_cbranch_scc1 L_fu
    buffer_store_dwordx4 v[68:71], v2, s[24:27], s8 offen sc1
    buffer_store_dwordx4 v[72:75], v2, s[24:27], s8 offen offset:256 sc1
L_fu:
    s_mov_b64 exec, -1
L_noffn:
    s_load_dwordx2 s[36:37], s[0:1], 32
    s_mov_b32 s38, 7864320
    s_mov_b32 s39, 0x20000
    s_load_dwordx2 s[40:41], s[0:1], 64
    s_mov_b32 s42, 1966080
    s_mov_b32 s43, 0x20000
    s_load_dwordx2 s[48:49], s[0:1], 72
    s_mov_b32 s50, 1280
    s_mov_b32 s51, 0x20000
    v_lshrrev_b32 v3, 5, v0
    v_lshl_add_u32 v3, s3, 1, v3
    v_and_b32 v68, 16, v0
    v_lshl_add_u32 v68, v46, 1, v68
    v_lshl_add_u32 v45, v3, 8, v68
    v_lshlrev_b32 v3, 2, v0
    v_lshl_add_u32 v3, s3, 8, v3
    s_mul_i32 s8, s5, 205
    s_lshr_b32 s8, s8, 11
    s_mul_i32 s9, s8, 10
    s_sub_u32 s62, s5, s9
    s_mul_i32 s63, s4, 3
    s_add_u32 s63, s63, s8
    s_lshl_b32 s8, s63, 2
    s_add_u32 s8, s8, s3
    s_lshl_b32 s9, s62, 7
    s_mul_i32 s10, s8, 81920
    s_add_u32 s10, s10, s9
    s_add_u32 s11, s10, 5120
    s_mul_i32 s12, s8, 20480
    s_add_u32 s12, s12, s9
    s_lshl_b32 s13, s63, 12
    s_lshl_b32 s14, s3, 6
    s_add_u32 s13, s13, s14
    s_add_u32 s13, s13, 204800
    s_mul_i32 s14, s8, 43691
    s_lshr_b32 s14, s14, 17
    s_mul_i32 s15, s14, 3
    s_sub_u32 s15, s8, s15
    s_mul_i32 s14, s14, 6144
    s_lshl_b32 s15, s15, 8
    s_add_u32 s14, s14, s15
    s_add_u32 s14, s14, 8192
    s_mul_i32 s52, s62, 24
    s_add_u32 s52, s52, s63
    s_lshl_b32 s52, s52, 8
    s_add_u32 s52, s52, 303104
    s_lshl_b32 s54, s6, 9
    s_add_u32 s54, s54, 376832
    s_lshl_b32 s53, s7, 2
    v_mul_u32_u24 v8, 10240, v47
    v_add_u32 v8, v8, v46
    v_mul_u32_u24 v9, 2560, v47
    v_add_u32 v9, v9, v46
    v_lshlrev_b32 v10, 3, v47
    v_lshl_add_u32 v10, v46, 5, v10
    v_and_b32 v44, 3, v0
    v_mul_u32_u24 v44, 1536, v44
    v_lshl_add_u32 v44, v47, 5, v44
    v_and_b32 v68, 4, v0
    v_lshl_add_u32 v44, v68, 2, v44
    v_and_b32 v12, 31, v0
    v_lshlrev_b32 v12, 4, v12
    s_waitcnt vmcnt(0) lgkmcnt(0)
    s_cmp_ge_u32 s5, 30
    s_cbranch_scc1 L_bm
L_bm:
    s_mul_i32 s8, s4, 512
    s_add_u32 s8, s8, 364544
    v_mov_b32 v68, 0
    v_and_b32 v71, 31, v0
    v_lshlrev_b32 v71, 2, v71
    v_and_b32 v78, 3, v0
    v_lshlrev_b32 v78, 2, v78
    s_cmp_eq_u32 s3, 3
    s_cbranch_scc0 L_s1x
    s_lshl_b32 s9, s5, 2
    s_add_u32 s9, s9, s8
    s_mov_b32 s84, 0
    s_mov_b32 s85, 0
    s_lshl_b32 s86, s7, 6
    s_add_u32 s86, s86, s54
    v_lshlrev_b32 v76, 1, v78
    v_lshlrev_b32 v79, 2, v78
    v_mov_b32 v81, s87
    v_mov_b32 v83, s87
L_s1c:
    ds_read_b32 v69, v78 offset:8704
    ds_read_b64 v[74:75], v76 offset:8736
    s_waitcnt lgkmcnt(0)
    v_add_u32_dpp v70, v69, v69 quad_perm:[1,0,3,2] row_mask:0xf bank_mask:0xf
    s_nop 1
    v_add_u32_dpp v70, v70, v70 quad_perm:[2,3,0,1] row_mask:0xf bank_mask:0xf
    v_xor_b32 v73, s93, v70
    s_mov_b64 exec, 1
    buffer_store_dword v73, v68, s[24:27], s9 offen
    s_mov_b64 exec, -1
    v_readfirstlane_b32 s61, v70
    s_cmp_eq_u32 s85, 1
    s_cbranch_scc1 L_s1m
    v_max_u32 v77, v74, v75
    v_cmp_eq_u32 vcc, -1, v77
    s_cbranch_vccnz L_s1n
    v_mov_b32 v80, v74
    v_mov_b32 v82, v75
    s_mov_b64 exec, 15
    buffer_store_dwordx4 v[80:83], v79, s[24:27], s86 offen
    s_add_u32 s86, s86, 917504
    s_cmp_eq_u32 s84, 1
    s_cbranch_scc1 L_s1u
    buffer_store_dwordx4 v[80:83], v79, s[24:27], s86 offen sc1
L_s1u:
    s_mov_b64 exec, -1
    s_mov_b32 s85, 1
L_s1m:
    s_cmp_ge_u32 s61, 432
    s_cbranch_scc1 L_s1d
L_s1n:
    buffer_load_dword v72, v71, s[24:27], s8 offen sc1
    s_waitcnt vmcnt(0)
    v_xor_b32 v72, s93, v72
    v_cmp_gt_u32 vcc, 0x400, v72
    s_nop 1
    v_cndmask_b32 v72, 0, v72, vcc
    v_max_i32 v72, 192, v72
    s_cmp_eq_u64 vcc, -1
    s_cselect_b32 s84, 1, 0
    v_mov_b32 v77, s84
    ds_write_b32 v68, v77 offset:8784
    v_add_u32_dpp v72, v72, v72 quad_perm:[1,0,3,2] row_mask:0xf bank_mask:0xf
    s_nop 1
    v_add_u32_dpp v72, v72, v72 quad_perm:[2,3,0,1] row_mask:0xf bank_mask:0xf
    s_nop 1
    v_add_u32_dpp v72, v72, v72 row_half_mirror row_mask:0xf bank_mask:0xf
    s_nop 1
    v_add_u32_dpp v72, v72, v72 row_ror:8 row_mask:0xf bank_mask:0xf
    v_mov_b32 v73, v72
    s_nop 1
    v_permlane16_swap_b32 v72, v73
    v_add_u32 v72, v72, v73
    v_lshlrev_b32 v69, 7, v69
    v_sub_u32 v72, v72, v69
    v_cmp_lt_i32 vcc, -64, v72
    s_nop 1
    v_cndmask_b32 v70, 1, 2, vcc
    v_cmp_gt_i32 vcc, -448, v72
    s_nop 1
    v_cndmask_b32 v70, v70, 0, vcc
    s_mov_b64 exec, 15
    ds_write_b32 v78, v70 offset:8720
    s_mov_b64 exec, -1
    s_branch L_s1c
L_s1x:
L_s1d:
    s_barrier
    s_cmp_ge_u32 s5, 30
    s_cbranch_scc1 L_ml
    v_and_b32 v68, 1, v47
    v_lshlrev_b32 v68, 4, v68
    v_lshrrev_b32 v68, v68, s87
    v_bfe_u32 v69, v68, 8, 8
    v_and_b32 v68, 0xff, v68
    s_mov_b32 s61, 4194303
L_fchk:
    s_and_b32 s8, s61, 3
    s_cselect_b32 s8, 0, 917504
    s_add_u32 s8, s8, s13
    buffer_load_dwordx2 v[16:17], v10, s[24:27], s8 offen sc1
    buffer_load_dwordx2 v[18:19], v10, s[24:27], s8 offen offset:256 sc1
    s_sub_u32 s61, s61, 1
    s_waitcnt vmcnt(0)
    s_cbranch_scc1 L_fok
    v_xor_b32 v16, v68, v16
    v_xor_b32 v17, v69, v17
    v_xor_b32 v18, v68, v18
    v_xor_b32 v19, v69, v19
    v_or3_b32 v80, v16, v17, v18
    v_or_b32 v81, v19, v80
    v_and_b32 v81, 0xff, v81
    v_cmp_ne_u32 vcc, 0, v81
    s_cbranch_vccnz L_fchk
L_fok:
    v_add_f32_dpp v16, v16, v16 quad_perm:[1,0,3,2] row_mask:0xf bank_mask:0xf
    v_add_f32_dpp v17, v17, v17 quad_perm:[1,0,3,2] row_mask:0xf bank_mask:0xf
    v_add_f32_dpp v18, v18, v18 quad_perm:[1,0,3,2] row_mask:0xf bank_mask:0xf
    v_add_f32_dpp v19, v19, v19 quad_perm:[1,0,3,2] row_mask:0xf bank_mask:0xf
    v_add_f32_dpp v16, v16, v16 quad_perm:[2,3,0,1] row_mask:0xf bank_mask:0xf
    v_add_f32_dpp v17, v17, v17 quad_perm:[2,3,0,1] row_mask:0xf bank_mask:0xf
    v_add_f32_dpp v18, v18, v18 quad_perm:[2,3,0,1] row_mask:0xf bank_mask:0xf
    v_add_f32_dpp v19, v19, v19 quad_perm:[2,3,0,1] row_mask:0xf bank_mask:0xf
    v_add_f32_dpp v16, v16, v16 row_half_mirror row_mask:0xf bank_mask:0xf
    v_add_f32_dpp v17, v17, v17 row_half_mirror row_mask:0xf bank_mask:0xf
    v_add_f32_dpp v18, v18, v18 row_half_mirror row_mask:0xf bank_mask:0xf
    v_add_f32_dpp v19, v19, v19 row_half_mirror row_mask:0xf bank_mask:0xf
    v_cvt_pk_bf16_f32 v16, v16, v16
    v_and_b32 v16, s55, v16
    v_cvt_pk_bf16_f32 v17, v17, v17
    v_and_b32 v17, s55, v17
    v_cvt_pk_bf16_f32 v18, v18, v18
    v_and_b32 v18, s55, v18
    v_cvt_pk_bf16_f32 v19, v19, v19
    v_and_b32 v19, s55, v19
    v_mul_f32 v68, v16, v16
    v_mul_f32 v68, 0x3d372713, v68
    v_fma_f32 v68, v68, v16, v16
    v_mul_f32 v68, 0xc0135761, v68
    v_exp_f32 v68, v68
    s_nop 0
    v_add_f32 v68, 1.0, v68
    v_rcp_f32 v68, v68
    s_nop 0
    v_mul_f32 v68, v68, v16
    v_cvt_pk_bf16_f32 v68, v68, v68
    v_and_b32 v68, s55, v68
    v_mul_f32 v68, v68, v18
    v_cvt_pk_bf16_f32 v68, v68, v68
    v_and_b32 v60, v4, v68
    v_and_b32 v61, v5, v68
    v_and_b32 v62, v6, v68
    v_and_b32 v63, v7, v68
    v_mul_f32 v69, v17, v17
    v_mul_f32 v69, 0x3d372713, v69
    v_fma_f32 v69, v69, v17, v17
    v_mul_f32 v69, 0xc0135761, v69
    v_exp_f32 v69, v69
    s_nop 0
    v_add_f32 v69, 1.0, v69
    v_rcp_f32 v69, v69
    s_nop 0
    v_mul_f32 v69, v69, v17
    v_cvt_pk_bf16_f32 v69, v69, v69
    v_and_b32 v69, s55, v69
    v_mul_f32 v69, v69, v19
    v_cvt_pk_bf16_f32 v69, v69, v69
    v_and_b32 v64, v4, v69
    v_and_b32 v65, v5, v69
    v_and_b32 v66, v6, v69
    v_and_b32 v67, v7, v69
L_ml:
    s_cmp_lg_u32 s3, 0
    s_cbranch_scc1 L_noml
    s_mov_b32 s61, 4194303
L_mchk:
    s_and_b32 s8, s61, 3
    s_cselect_b32 s8, 0, 917504
    s_add_u32 s8, s8, s54
    buffer_load_dwordx4 v[28:31], v12, s[24:27], s8 offen sc1
    s_sub_u32 s61, s61, 1
    s_waitcnt vmcnt(0)
    s_cbranch_scc1 L_mok
    v_xor_b32 v29, s87, v29
    v_xor_b32 v31, s87, v31
    v_or_b32 v29, v29, v31
    v_cmp_ne_u32 vcc, 0, v29
    s_cbranch_vccnz L_mchk
L_mok:
    v_mov_b32 v14, v28
    v_mov_b32 v15, v30
    v_mov_b32 v68, v14
    s_nop 1
    v_max_f32_dpp v68, v68, v68 quad_perm:[1,0,3,2] row_mask:0xf bank_mask:0xf
    s_nop 1
    v_max_f32_dpp v68, v68, v68 quad_perm:[2,3,0,1] row_mask:0xf bank_mask:0xf
    s_nop 1
    v_max_f32_dpp v68, v68, v68 row_half_mirror row_mask:0xf bank_mask:0xf
    s_nop 1
    v_max_f32_dpp v68, v68, v68 row_ror:8 row_mask:0xf bank_mask:0xf
    v_mov_b32 v69, v68
    s_nop 1
    v_permlane16_swap_b32 v68, v69
    v_max_f32 v68, v68, v69
    v_sub_f32 v68, v14, v68
    v_exp_f32 v68, v68
    s_nop 0
    v_mul_f32 v70, v68, v15
    s_nop 1
    v_add_f32_dpp v70, v70, v70 quad_perm:[1,0,3,2] row_mask:0xf bank_mask:0xf
    s_nop 1
    v_add_f32_dpp v70, v70, v70 quad_perm:[2,3,0,1] row_mask:0xf bank_mask:0xf
    s_nop 1
    v_add_f32_dpp v70, v70, v70 row_half_mirror row_mask:0xf bank_mask:0xf
    s_nop 1
    v_add_f32_dpp v70, v70, v70 row_ror:8 row_mask:0xf bank_mask:0xf
    v_mov_b32 v69, v70
    s_nop 1
    v_permlane16_swap_b32 v70, v69
    v_add_f32 v70, v70, v69
    v_rcp_f32 v70, v70
    s_nop 0
    v_mul_f32 v68, v68, v70
    v_subrev_u32 v69, s53, v0
    v_cmp_gt_u32 vcc, 4, v69
    v_lshlrev_b32 v69, 2, v69
    s_and_saveexec_b64 s[8:9], vcc
    ds_write_b32 v69, v68 offset:8768
    s_mov_b64 exec, -1
    s_waitcnt lgkmcnt(0)
L_noml:
    s_mul_i32 s8, s4, 512
    s_add_u32 s8, s8, 364544
    v_mov_b32 v68, 0
    v_and_b32 v71, 31, v0
    v_lshlrev_b32 v71, 2, v71
    v_and_b32 v78, 3, v0
    v_lshlrev_b32 v78, 2, v78
    s_cmp_eq_u32 s3, 3
    s_cbranch_scc0 L_s2x
    s_lshl_b32 s9, s5, 2
    s_add_u32 s9, s9, s8
L_s2c:
    ds_read_b32 v69, v78 offset:8704
    s_waitcnt lgkmcnt(0)
    v_add_u32_dpp v70, v69, v69 quad_perm:[1,0,3,2] row_mask:0xf bank_mask:0xf
    s_nop 1
    v_add_u32_dpp v70, v70, v70 quad_perm:[2,3,0,1] row_mask:0xf bank_mask:0xf
    v_xor_b32 v73, s93, v70
    s_mov_b64 exec, 1
    buffer_store_dword v73, v68, s[24:27], s9 offen
    s_mov_b64 exec, -1
    v_readfirstlane_b32 s61, v70
    s_cmp_ge_u32 s61, 684
    s_cbranch_scc1 L_s2d
L_s2n:
    buffer_load_dword v72, v71, s[24:27], s8 offen sc1
    s_waitcnt vmcnt(0)
    v_xor_b32 v72, s93, v72
    v_cmp_gt_u32 vcc, 0x400, v72
    s_nop 1
    v_cndmask_b32 v72, 0, v72, vcc
    v_max_i32 v72, 192, v72
    s_nop 1
    v_add_u32_dpp v72, v72, v72 quad_perm:[1,0,3,2] row_mask:0xf bank_mask:0xf
    s_nop 1
    v_add_u32_dpp v72, v72, v72 quad_perm:[2,3,0,1] row_mask:0xf bank_mask:0xf
    s_nop 1
    v_add_u32_dpp v72, v72, v72 row_half_mirror row_mask:0xf bank_mask:0xf
    s_nop 1
    v_add_u32_dpp v72, v72, v72 row_ror:8 row_mask:0xf bank_mask:0xf
    v_mov_b32 v73, v72
    s_nop 1
    v_permlane16_swap_b32 v72, v73
    v_add_u32 v72, v72, v73
    v_lshlrev_b32 v69, 7, v69
    v_sub_u32 v72, v72, v69
    v_cmp_lt_i32 vcc, -64, v72
    s_nop 1
    v_cndmask_b32 v70, 1, 2, vcc
    v_cmp_gt_i32 vcc, -448, v72
    s_nop 1
    v_cndmask_b32 v70, v70, 0, vcc
    s_mov_b64 exec, 15
    ds_write_b32 v78, v70 offset:8720
    s_mov_b64 exec, -1
    s_branch L_s2c
L_s2x:
L_s2d:
    v_and_b32 v13, 3, v0
    v_lshlrev_b32 v13, 3, v13
    v_lshrrev_b32 v13, v13, s87
    s_barrier
    s_cmp_ge_u32 s5, 30
    s_cbranch_scc1 L_nowo
    buffer_load_dwordx4 v[20:23], v9, s[40:43], s12 offen offset:0 nt
    buffer_load_dwordx4 v[24:27], v9, s[40:43], s12 offen offset:1280 nt
    buffer_load_dwordx4 v[96:99], v8, s[36:39], s10 offen offset:0 nt
    buffer_load_dwordx4 v[100:103], v8, s[36:39], s10 offen offset:1280 nt
    buffer_load_dwordx4 v[104:107], v8, s[36:39], s10 offen offset:2560 nt
L_nowo:
    s_barrier
L_b2:
    s_cmp_ge_u32 s5, 30
    s_cbranch_scc1 L_spare_b
    s_barrier
    buffer_load_dwordx4 v[28:31], v44, s[24:27], s14 offen offset:0 sc1
    buffer_load_dwordx4 v[32:35], v44, s[24:27], s14 offen offset:768 sc1
    buffer_load_dwordx4 v[108:111], v8, s[36:39], s10 offen offset:3840 nt
    buffer_load_dwordx4 v[112:115], v8, s[36:39], s11 offen offset:0 nt
    buffer_load_dwordx4 v[116:119], v8, s[36:39], s11 offen offset:1280 nt
    buffer_load_dwordx4 v[120:123], v8, s[36:39], s11 offen offset:2560 nt
    buffer_load_dwordx4 v[124:127], v8, s[36:39], s11 offen offset:3840 nt
    s_waitcnt vmcnt(5)
    v_mfma_f32_16x16x32_bf16 v[48:51], v[60:63], v[20:23], 0
    v_mfma_f32_16x16x32_bf16 v[48:51], v[64:67], v[24:27], v[48:51]
    v_xor_b32 v28, s88, v28
    v_xor_b32 v29, s89, v29
    v_xor_b32 v30, s90, v30
    v_xor_b32 v31, s91, v31
    v_xor_b32 v32, s88, v32
    v_xor_b32 v33, s89, v33
    v_xor_b32 v34, s90, v34
    v_xor_b32 v35, s91, v35
    v_or3_b32 v80, v28, v29, v30
    v_or3_b32 v81, v31, v32, v33
    v_or3_b32 v82, v34, v35, v80
    v_or_b32 v83, v81, v82
    v_and_b32 v83, 0xff, v83
    v_cmp_ne_u32 vcc, 0, v83
    s_cbranch_vccz L_ook
    s_mov_b32 s61, 4194303
L_ochk:
    s_and_b32 s8, s61, 31
    s_cselect_b32 s8, 0, 385024
    s_add_u32 s8, s8, s14
    buffer_load_dwordx4 v[28:31], v44, s[24:27], s8 offen offset:0 sc1
    buffer_load_dwordx4 v[32:35], v44, s[24:27], s8 offen offset:768 sc1
    s_sub_u32 s61, s61, 1
    s_waitcnt vmcnt(0)
    s_cbranch_scc1 L_ook
    v_xor_b32 v28, s88, v28
    v_xor_b32 v29, s89, v29
    v_xor_b32 v30, s90, v30
    v_xor_b32 v31, s91, v31
    v_xor_b32 v32, s88, v32
    v_xor_b32 v33, s89, v33
    v_xor_b32 v34, s90, v34
    v_xor_b32 v35, s91, v35
    v_or3_b32 v80, v28, v29, v30
    v_or3_b32 v81, v31, v32, v33
    v_or3_b32 v82, v34, v35, v80
    v_or_b32 v83, v81, v82
    v_and_b32 v83, 0xff, v83
    v_cmp_ne_u32 vcc, 0, v83
    s_cbranch_vccnz L_ochk
L_ook:
    v_pk_add_f32 v[28:29], v[28:29], v[32:33]
    v_pk_add_f32 v[30:31], v[30:31], v[34:35]
    s_nop 0
    v_add_f32_dpp v28, v28, v28 quad_perm:[1,0,3,2] row_mask:0xf bank_mask:0xf
    v_add_f32_dpp v29, v29, v29 quad_perm:[1,0,3,2] row_mask:0xf bank_mask:0xf
    v_add_f32_dpp v30, v30, v30 quad_perm:[1,0,3,2] row_mask:0xf bank_mask:0xf
    v_add_f32_dpp v31, v31, v31 quad_perm:[1,0,3,2] row_mask:0xf bank_mask:0xf
    v_add_f32_dpp v28, v28, v28 quad_perm:[2,3,0,1] row_mask:0xf bank_mask:0xf
    v_add_f32_dpp v29, v29, v29 quad_perm:[2,3,0,1] row_mask:0xf bank_mask:0xf
    v_add_f32_dpp v30, v30, v30 quad_perm:[2,3,0,1] row_mask:0xf bank_mask:0xf
    v_add_f32_dpp v31, v31, v31 quad_perm:[2,3,0,1] row_mask:0xf bank_mask:0xf
    v_cvt_pk_bf16_f32 v28, v28, v28
    v_cvt_pk_bf16_f32 v29, v29, v29
    v_cvt_pk_bf16_f32 v30, v30, v30
    v_cvt_pk_bf16_f32 v31, v31, v31
    v_and_b32 v60, v4, v28
    v_and_b32 v61, v5, v28
    v_and_b32_dpp v62, v28, v6 row_half_mirror row_mask:0xf bank_mask:0xf
    v_and_b32_dpp v63, v28, v7 row_half_mirror row_mask:0xf bank_mask:0xf
    v_and_b32 v64, v4, v29
    v_and_b32 v65, v5, v29
    v_and_b32_dpp v66, v29, v6 row_half_mirror row_mask:0xf bank_mask:0xf
    v_and_b32_dpp v67, v29, v7 row_half_mirror row_mask:0xf bank_mask:0xf
    v_mfma_f32_16x16x32_bf16 v[48:51], v[60:63], v[96:99], v[48:51]
    v_and_b32 v60, v4, v30
    v_and_b32 v61, v5, v30
    v_and_b32_dpp v62, v30, v6 row_half_mirror row_mask:0xf bank_mask:0xf
    v_and_b32_dpp v63, v30, v7 row_half_mirror row_mask:0xf bank_mask:0xf
    v_mfma_f32_16x16x32_bf16 v[48:51], v[64:67], v[100:103], v[48:51]
    v_and_b32 v64, v4, v31
    v_and_b32 v65, v5, v31
    v_and_b32_dpp v66, v31, v6 row_half_mirror row_mask:0xf bank_mask:0xf
    v_and_b32_dpp v67, v31, v7 row_half_mirror row_mask:0xf bank_mask:0xf
    v_mfma_f32_16x16x32_bf16 v[48:51], v[60:63], v[104:107], v[48:51]
    v_and_b32_dpp v60, v28, v4 row_half_mirror row_mask:0xf bank_mask:0xf
    v_and_b32_dpp v61, v28, v5 row_half_mirror row_mask:0xf bank_mask:0xf
    v_and_b32 v62, v6, v28
    v_and_b32 v63, v7, v28
    s_waitcnt vmcnt(4)
    v_mfma_f32_16x16x32_bf16 v[48:51], v[64:67], v[108:111], v[48:51]
    v_and_b32_dpp v64, v29, v4 row_half_mirror row_mask:0xf bank_mask:0xf
    v_and_b32_dpp v65, v29, v5 row_half_mirror row_mask:0xf bank_mask:0xf
    v_and_b32 v66, v6, v29
    v_and_b32 v67, v7, v29
    s_waitcnt vmcnt(3)
    v_mfma_f32_16x16x32_bf16 v[48:51], v[60:63], v[112:115], v[48:51]
    v_and_b32_dpp v60, v30, v4 row_half_mirror row_mask:0xf bank_mask:0xf
    v_and_b32_dpp v61, v30, v5 row_half_mirror row_mask:0xf bank_mask:0xf
    v_and_b32 v62, v6, v30
    v_and_b32 v63, v7, v30
    s_waitcnt vmcnt(2)
    v_mfma_f32_16x16x32_bf16 v[48:51], v[64:67], v[116:119], v[48:51]
    v_and_b32_dpp v64, v31, v4 row_half_mirror row_mask:0xf bank_mask:0xf
    v_and_b32_dpp v65, v31, v5 row_half_mirror row_mask:0xf bank_mask:0xf
    v_and_b32 v66, v6, v31
    v_and_b32 v67, v7, v31
    s_waitcnt vmcnt(1)
    v_mfma_f32_16x16x32_bf16 v[48:51], v[60:63], v[120:123], v[48:51]
    s_waitcnt vmcnt(0)
    v_mfma_f32_16x16x32_bf16 v[48:51], v[64:67], v[124:127], v[48:51]
    s_mov_b32 exec_lo, 0x00ff00ff
    s_mov_b32 exec_hi, 0xff00ff00
    s_nop 5
    ds_write_b128 v45, v[48:51] offset:6656
    s_mov_b64 exec, -1
    s_waitcnt lgkmcnt(0)
    s_barrier
    s_cmp_lg_u32 s3, 0
    s_cbranch_scc1 L_end
    ds_read2st64_b32 v[68:69], v3 offset0:26 offset1:27
    ds_read2st64_b32 v[70:71], v3 offset0:28 offset1:29
    ds_read2st64_b32 v[72:73], v3 offset0:30 offset1:31
    ds_read2st64_b32 v[74:75], v3 offset0:32 offset1:33
    s_waitcnt lgkmcnt(2)
    v_pk_add_f32 v[68:69], v[68:69], v[70:71]
    s_waitcnt lgkmcnt(1)
    v_pk_add_f32 v[68:69], v[68:69], v[72:73]
    s_waitcnt lgkmcnt(0)
    v_pk_add_f32 v[68:69], v[68:69], v[74:75]
    v_add_f32 v68, v68, v69
    v_bfi_b32 v68, s92, v13, v68
    buffer_store_dword v68, v3, s[24:27], s52 offen sc1
    s_endpgm
L_spare_b:
    s_sub_u32 s8, s2, 240
    s_cmp_ge_u32 s8, 10
    s_cbranch_scc1 L_end
    s_mul_i32 s9, s8, 6144
    s_lshl_b32 s10, s3, 6
    s_add_u32 s9, s9, s10
    s_add_u32 s9, s9, 303104
    s_lshl_b32 s11, s8, 7
    s_lshl_b32 s10, s3, 5
    s_add_u32 s11, s11, s10
    s_add_u32 s10, s9, 3072
    v_and_b32 v2, 15, v0
    v_lshrrev_b32 v1, 4, v0
    v_lshlrev_b32 v1, 8, v1
    v_lshl_add_u32 v1, v2, 2, v1
    v_lshlrev_b32 v2, 1, v2
    v_and_b32 v13, 0xff, v13
    buffer_load_ushort v14, v2, s[20:23], s11 offen
    s_mov_b32 s61, 4194304
    s_waitcnt vmcnt(0)
    v_lshlrev_b32 v14, 16, v14
    buffer_load_dword v104, v1, s[24:27], s9 offen offset:0 sc1
    buffer_load_dword v105, v1, s[24:27], s9 offen offset:1024 sc1
    buffer_load_dword v106, v1, s[24:27], s9 offen offset:2048 sc1
    buffer_load_dword v107, v1, s[24:27], s10 offen offset:0 sc1
    buffer_load_dword v108, v1, s[24:27], s10 offen offset:1024 sc1
    buffer_load_dword v109, v1, s[24:27], s10 offen offset:2048 sc1
    buffer_load_dword v112, v1, s[24:27], s9 offen offset:0 sc1
    buffer_load_dword v113, v1, s[24:27], s9 offen offset:1024 sc1
    buffer_load_dword v114, v1, s[24:27], s9 offen offset:2048 sc1
    buffer_load_dword v115, v1, s[24:27], s10 offen offset:0 sc1
    buffer_load_dword v116, v1, s[24:27], s10 offen offset:1024 sc1
    buffer_load_dword v117, v1, s[24:27], s10 offen offset:2048 sc1
L_ychk:
    buffer_load_dword v120, v1, s[24:27], s9 offen offset:0 sc1
    buffer_load_dword v121, v1, s[24:27], s9 offen offset:1024 sc1
    buffer_load_dword v122, v1, s[24:27], s9 offen offset:2048 sc1
    buffer_load_dword v123, v1, s[24:27], s10 offen offset:0 sc1
    buffer_load_dword v124, v1, s[24:27], s10 offen offset:1024 sc1
    buffer_load_dword v125, v1, s[24:27], s10 offen offset:2048 sc1
    s_waitcnt vmcnt(12)
    v_xor_b32 v104, v13, v104
    v_xor_b32 v105, v13, v105
    v_xor_b32 v106, v13, v106
    v_xor_b32 v107, v13, v107
    v_xor_b32 v108, v13, v108
    v_xor_b32 v109, v13, v109
    v_or3_b32 v68, v104, v105, v106
    v_or3_b32 v69, v107, v108, v109
    v_or_b32 v70, v68, v69
    v_and_b32 v70, 0xff, v70
    v_cmp_ne_u32 vcc, 0, v70
    v_pk_add_f32 v[96:97], v[104:105], v[106:107]
    v_pk_add_f32 v[96:97], v[96:97], v[108:109]
    s_cbranch_vccz L_yok
    buffer_load_dword v104, v1, s[24:27], s9 offen offset:0 sc1
    buffer_load_dword v105, v1, s[24:27], s9 offen offset:1024 sc1
    buffer_load_dword v106, v1, s[24:27], s9 offen offset:2048 sc1
    buffer_load_dword v107, v1, s[24:27], s10 offen offset:0 sc1
    buffer_load_dword v108, v1, s[24:27], s10 offen offset:1024 sc1
    buffer_load_dword v109, v1, s[24:27], s10 offen offset:2048 sc1
    s_waitcnt vmcnt(12)
    v_xor_b32 v112, v13, v112
    v_xor_b32 v113, v13, v113
    v_xor_b32 v114, v13, v114
    v_xor_b32 v115, v13, v115
    v_xor_b32 v116, v13, v116
    v_xor_b32 v117, v13, v117
    v_or3_b32 v68, v112, v113, v114
    v_or3_b32 v69, v115, v116, v117
    v_or_b32 v70, v68, v69
    v_and_b32 v70, 0xff, v70
    v_cmp_ne_u32 vcc, 0, v70
    v_pk_add_f32 v[96:97], v[112:113], v[114:115]
    v_pk_add_f32 v[96:97], v[96:97], v[116:117]
    s_cbranch_vccz L_yok
    buffer_load_dword v112, v1, s[24:27], s9 offen offset:0 sc1
    buffer_load_dword v113, v1, s[24:27], s9 offen offset:1024 sc1
    buffer_load_dword v114, v1, s[24:27], s9 offen offset:2048 sc1
    buffer_load_dword v115, v1, s[24:27], s10 offen offset:0 sc1
    buffer_load_dword v116, v1, s[24:27], s10 offen offset:1024 sc1
    buffer_load_dword v117, v1, s[24:27], s10 offen offset:2048 sc1
    s_waitcnt vmcnt(12)
    v_xor_b32 v120, v13, v120
    v_xor_b32 v121, v13, v121
    v_xor_b32 v122, v13, v122
    v_xor_b32 v123, v13, v123
    v_xor_b32 v124, v13, v124
    v_xor_b32 v125, v13, v125
    v_or3_b32 v68, v120, v121, v122
    v_or3_b32 v69, v123, v124, v125
    v_or_b32 v70, v68, v69
    v_and_b32 v70, 0xff, v70
    v_cmp_ne_u32 vcc, 0, v70
    v_pk_add_f32 v[96:97], v[120:121], v[122:123]
    v_pk_add_f32 v[96:97], v[96:97], v[124:125]
    s_cbranch_vccz L_yok
    s_sub_u32 s61, s61, 1
    s_cbranch_scc0 L_ychk
L_yok:
    v_add_f32 v96, v96, v97
    v_mov_b32 v97, v96
    s_nop 1
    v_permlane16_swap_b32 v96, v97
    v_add_f32 v96, v96, v97
    v_mov_b32 v97, v96
    s_nop 1
    v_permlane32_swap_b32 v96, v97
    v_add_f32 v96, v96, v97
    v_add_f32 v96, v96, v14
    v_cvt_pk_bf16_f32 v96, v96, v96
    s_mov_b64 exec, 0xffff
    buffer_store_short v96, v2, s[48:51], s11 offen
    s_lshl_b32 s8, s2, 2
    s_add_u32 s8, s8, s3
    s_cmp_lg_u32 s8, 963
    s_cbranch_scc1 L_fin
    v_mov_b32 v2, 0
    v_mov_b32 v3, s87
    s_mov_b64 exec, 1
    buffer_store_dword v3, v2, s[24:27], 0 offen
L_fin:
    s_endpgm
.p2align 8
L_stream:
    s_mov_b32 s30, 100663296
    s_mov_b32 s31, 0x20000
    s_mov_b32 s34, 100663296
    s_mov_b32 s35, 0x20000
    s_mul_i32 s52, s6, 3145728
    s_lshl_b32 s8, s7, 2
    s_add_u32 s8, s8, s3
    s_mul_i32 s9, s7, 12288
    s_add_u32 s52, s52, s9
    s_mul_i32 s9, s3, 3072
    s_add_u32 s52, s52, s9
    v_lshrrev_b32 v1, 3, v0
    v_mul_u32_u24 v1, 384, v1
    v_and_b32 v2, 7, v0
    v_lshl_add_u32 v1, v2, 4, v1
    s_mul_i32 s59, s6, 616
    s_add_u32 s59, s59, s8
    s_mul_i32 s60, s6, 3145728
    s_add_u32 s53, s59, 0
    s_and_b32 s53, s53, 1023
    s_mul_i32 s53, s53, 3072
    s_add_u32 s53, s53, s60
    s_waitcnt lgkmcnt(0)
    buffer_load_dwordx4 v[76:79], v1, s[28:31], s53 offen offset:0 nt
    buffer_load_dwordx4 v[80:83], v1, s[28:31], s53 offen offset:128 nt
    s_barrier
    buffer_load_dwordx4 v[84:87], v1, s[28:31], s53 offen offset:256 nt
    s_add_u32 s53, s59, 32
    s_and_b32 s53, s53, 1023
    s_mul_i32 s53, s53, 3072
    s_add_u32 s53, s53, s60
    buffer_load_dwordx4 v[88:91], v1, s[28:31], s53 offen offset:0 nt
    buffer_load_dwordx4 v[92:95], v1, s[28:31], s53 offen offset:128 nt
    s_load_dword s87, s[24:25], 0
    v_and_b32 v2, 1, v0
    v_lshlrev_b32 v2, 4, v2
    v_mov_b32 v3, 0xffff
    v_lshlrev_b32 v3, v2, v3
    v_bfe_u32 v2, v0, 1, 2
    v_cmp_eq_u32 vcc, 0, v2
    s_nop 1
    v_cndmask_b32 v4, 0, v3, vcc
    v_cmp_eq_u32 vcc, 1, v2
    s_nop 1
    v_cndmask_b32 v5, 0, v3, vcc
    v_cmp_eq_u32 vcc, 2, v2
    s_nop 1
    v_cndmask_b32 v6, 0, v3, vcc
    v_cmp_eq_u32 vcc, 3, v2
    s_nop 1
    v_cndmask_b32 v7, 0, v3, vcc
    v_mov_b32 v40, 0
    v_mov_b32 v41, 0
    v_mov_b32 v42, 0
    v_mov_b32 v43, 0
    v_mov_b32 v44, 0
    v_mov_b32 v45, 0
    v_mov_b32 v46, 0
    v_mov_b32 v47, 0
    v_mov_b32 v48, 0
    v_mov_b32 v49, 0
    v_mov_b32 v50, 0
    v_mov_b32 v51, 0
    v_mov_b32 v52, 0
    v_mov_b32 v53, 0
    v_mov_b32 v54, 0
    v_mov_b32 v55, 0
    v_mov_b32 v56, 0
    v_mov_b32 v57, 0
    v_mov_b32 v58, 0
    v_mov_b32 v59, 0
    v_mov_b32 v60, 0
    v_mov_b32 v61, 0
    v_mov_b32 v62, 0
    v_mov_b32 v63, 0
    v_mov_b32 v64, 0
    v_mov_b32 v65, 0
    v_mov_b32 v66, 0
    v_mov_b32 v67, 0
    v_mov_b32 v68, 0
    v_mov_b32 v69, 0
    v_mov_b32 v70, 0
    v_mov_b32 v71, 0
    v_mov_b32 v72, 0xff800000
    s_mov_b32 s56, 0x3d93cd3a
    s_mov_b32 s57, 0x3fb8aa3b
    v_and_b32 v2, 7, v0
    v_lshlrev_b32 v2, 4, v2
    v_lshrrev_b32 v3, 5, v0
    v_lshl_add_u32 v3, s3, 1, v3
    v_mul_u32_u24 v3, 768, v3
    v_lshl_add_u32 v3, v2, 1, v3
    v_and_b32 v74, 16, v0
    v_add_u32 v3, v3, v74
    s_waitcnt vmcnt(4)
    buffer_load_dwordx4 v[96:99], v1, s[28:31], s53 offen offset:256 nt
    s_add_u32 s53, s59, 64
    s_and_b32 s53, s53, 1023
    s_mul_i32 s53, s53, 3072
    s_add_u32 s53, s53, s60
    s_waitcnt vmcnt(4)
    buffer_load_dwordx4 v[100:103], v1, s[28:31], s53 offen offset:0 nt
    s_waitcnt vmcnt(4)
    buffer_load_dwordx4 v[104:107], v1, s[28:31], s53 offen offset:128 nt
    s_waitcnt vmcnt(4)
    buffer_load_dwordx4 v[108:111], v1, s[28:31], s53 offen offset:256 nt
    s_add_u32 s53, s59, 96
    s_and_b32 s53, s53, 1023
    s_mul_i32 s53, s53, 3072
    s_add_u32 s53, s53, s60
    s_waitcnt vmcnt(4)
    buffer_load_dwordx4 v[112:115], v1, s[28:31], s53 offen offset:0 nt
    s_waitcnt vmcnt(4)
    buffer_load_dwordx4 v[116:119], v1, s[28:31], s53 offen offset:128 nt
    s_waitcnt vmcnt(4)
    buffer_load_dwordx4 v[120:123], v1, s[28:31], s53 offen offset:256 nt
    s_add_u32 s53, s59, 128
    s_and_b32 s53, s53, 1023
    s_mul_i32 s53, s53, 3072
    s_add_u32 s53, s53, s60
    s_waitcnt vmcnt(4)
    buffer_load_dwordx4 v[124:127], v1, s[28:31], s53 offen offset:0 nt
    s_waitcnt vmcnt(4)
    buffer_load_dwordx4 v[128:131], v1, s[28:31], s53 offen offset:128 nt
    s_waitcnt vmcnt(4)
    buffer_load_dwordx4 v[132:135], v1, s[28:31], s53 offen offset:256 nt
    s_add_u32 s53, s59, 160
    s_and_b32 s53, s53, 1023
    s_mul_i32 s53, s53, 3072
    s_add_u32 s53, s53, s60
    s_waitcnt vmcnt(4)
    buffer_load_dwordx4 v[136:139], v1, s[28:31], s53 offen offset:0 nt
    s_waitcnt vmcnt(4)
    buffer_load_dwordx4 v[140:143], v1, s[28:31], s53 offen offset:128 nt
    s_barrier
    s_waitcnt vmcnt(4)
    buffer_load_dwordx4 v[144:147], v1, s[28:31], s53 offen offset:256 nt
    s_add_u32 s53, s59, 192
    s_and_b32 s53, s53, 1023
    s_mul_i32 s53, s53, 3072
    s_add_u32 s53, s53, s60
    s_waitcnt vmcnt(4)
    buffer_load_dwordx4 v[148:151], v1, s[28:31], s53 offen offset:0 nt
    s_waitcnt vmcnt(4)
    buffer_load_dwordx4 v[152:155], v1, s[28:31], s53 offen offset:128 nt
    s_waitcnt vmcnt(4)
    buffer_load_dwordx4 v[156:159], v1, s[28:31], s53 offen offset:256 nt
    s_add_u32 s53, s59, 224
    s_and_b32 s53, s53, 1023
    s_mul_i32 s53, s53, 3072
    s_add_u32 s53, s53, s60
    s_waitcnt vmcnt(4)
    buffer_load_dwordx4 v[160:163], v1, s[28:31], s53 offen offset:0 nt
    s_waitcnt vmcnt(4)
    buffer_load_dwordx4 v[164:167], v1, s[28:31], s53 offen offset:128 nt
    s_waitcnt vmcnt(4)
    buffer_load_dwordx4 v[168:171], v1, s[28:31], s53 offen offset:256 nt
    s_add_u32 s53, s59, 256
    s_and_b32 s53, s53, 1023
    s_mul_i32 s53, s53, 3072
    s_add_u32 s53, s53, s60
    s_waitcnt vmcnt(4)
    buffer_load_dwordx4 v[172:175], v1, s[28:31], s53 offen offset:0 nt
    s_waitcnt vmcnt(4)
    buffer_load_dwordx4 v[176:179], v1, s[28:31], s53 offen offset:128 nt
    s_waitcnt vmcnt(4)
    buffer_load_dwordx4 v[180:183], v1, s[28:31], s53 offen offset:256 nt
    s_add_u32 s53, s59, 288
    s_and_b32 s53, s53, 1023
    s_mul_i32 s53, s53, 3072
    s_add_u32 s53, s53, s60
    s_waitcnt vmcnt(4)
    buffer_load_dwordx4 v[184:187], v1, s[28:31], s53 offen offset:0 nt
    s_waitcnt vmcnt(4)
    buffer_load_dwordx4 v[188:191], v1, s[28:31], s53 offen offset:128 nt
    s_waitcnt vmcnt(4)
    buffer_load_dwordx4 v[192:195], v1, s[28:31], s53 offen offset:256 nt
    s_add_u32 s53, s59, 320
    s_and_b32 s53, s53, 1023
    s_mul_i32 s53, s53, 3072
    s_add_u32 s53, s53, s60
    s_waitcnt vmcnt(4)
    buffer_load_dwordx4 v[196:199], v1, s[28:31], s53 offen offset:0 nt
    s_waitcnt vmcnt(4)
    buffer_load_dwordx4 v[200:203], v1, s[28:31], s53 offen offset:128 nt
    s_waitcnt vmcnt(4)
    buffer_load_dwordx4 v[204:207], v1, s[28:31], s53 offen offset:256 nt
    s_add_u32 s53, s59, 352
    s_and_b32 s53, s53, 1023
    s_mul_i32 s53, s53, 3072
    s_add_u32 s53, s53, s60
    s_waitcnt vmcnt(4)
    buffer_load_dwordx4 v[208:211], v1, s[28:31], s53 offen offset:0 nt
    s_waitcnt vmcnt(4)
    buffer_load_dwordx4 v[212:215], v1, s[28:31], s53 offen offset:128 nt
    s_waitcnt vmcnt(4)
    buffer_load_dwordx4 v[216:219], v1, s[28:31], s53 offen offset:256 nt
    s_add_u32 s53, s59, 384
    s_and_b32 s53, s53, 1023
    s_mul_i32 s53, s53, 3072
    s_add_u32 s53, s53, s60
    s_waitcnt vmcnt(4)
    buffer_load_dwordx4 v[220:223], v1, s[28:31], s53 offen offset:0 nt
    s_waitcnt vmcnt(4)
    buffer_load_dwordx4 v[224:227], v1, s[28:31], s53 offen offset:128 nt
    s_waitcnt vmcnt(4)
    buffer_load_dwordx4 v[228:231], v1, s[28:31], s53 offen offset:256 nt
    s_add_u32 s53, s59, 416
    s_and_b32 s53, s53, 1023
    s_mul_i32 s53, s53, 3072
    s_add_u32 s53, s53, s60
    s_waitcnt vmcnt(4)
    buffer_load_dwordx4 v[232:235], v1, s[28:31], s53 offen offset:0 nt
    s_waitcnt vmcnt(4)
    buffer_load_dwordx4 v[236:239], v1, s[28:31], s53 offen offset:128 nt
    s_waitcnt vmcnt(4)
    buffer_load_dwordx4 v[240:243], v1, s[28:31], s53 offen offset:256 nt
    s_add_u32 s53, s59, 448
    s_and_b32 s53, s53, 1023
    s_mul_i32 s53, s53, 3072
    s_add_u32 s53, s53, s60
    s_waitcnt vmcnt(4)
    buffer_load_dwordx4 v[244:247], v1, s[28:31], s53 offen offset:0 nt
    s_barrier
    ds_read_b128 v[8:11], v2 offset:6144
    ds_read_b128 v[12:15], v2 offset:6272
    ds_read_b128 v[16:19], v2 offset:6400
    s_waitcnt lgkmcnt(0)
    v_dot2c_f32_bf16 v40, v76, v8
    v_dot2c_f32_bf16 v41, v88, v8
    v_dot2c_f32_bf16 v42, v100, v8
    v_dot2c_f32_bf16 v40, v77, v9
    v_dot2c_f32_bf16 v41, v89, v9
    v_dot2c_f32_bf16 v42, v101, v9
    v_dot2c_f32_bf16 v40, v78, v10
    v_dot2c_f32_bf16 v41, v90, v10
    v_dot2c_f32_bf16 v42, v102, v10
    v_dot2c_f32_bf16 v40, v79, v11
    v_dot2c_f32_bf16 v41, v91, v11
    v_dot2c_f32_bf16 v42, v103, v11
    v_dot2c_f32_bf16 v40, v80, v12
    v_dot2c_f32_bf16 v41, v92, v12
    v_dot2c_f32_bf16 v42, v104, v12
    v_dot2c_f32_bf16 v40, v81, v13
    v_dot2c_f32_bf16 v41, v93, v13
    v_dot2c_f32_bf16 v42, v105, v13
    v_dot2c_f32_bf16 v40, v82, v14
    v_dot2c_f32_bf16 v41, v94, v14
    v_dot2c_f32_bf16 v42, v106, v14
    v_dot2c_f32_bf16 v40, v83, v15
    v_dot2c_f32_bf16 v41, v95, v15
    v_dot2c_f32_bf16 v42, v107, v15
    v_dot2c_f32_bf16 v40, v84, v16
    v_dot2c_f32_bf16 v41, v96, v16
    v_dot2c_f32_bf16 v42, v108, v16
    v_dot2c_f32_bf16 v40, v85, v17
    v_dot2c_f32_bf16 v41, v97, v17
    v_dot2c_f32_bf16 v42, v109, v17
    v_dot2c_f32_bf16 v40, v86, v18
    v_dot2c_f32_bf16 v41, v98, v18
    v_dot2c_f32_bf16 v42, v110, v18
    v_dot2c_f32_bf16 v40, v87, v19
    v_dot2c_f32_bf16 v41, v99, v19
    v_dot2c_f32_bf16 v42, v111, v19
    s_nop 0
    v_add_f32_dpp v40, v40, v40 quad_perm:[1,0,3,2] row_mask:0xf bank_mask:0xf
    v_add_f32_dpp v41, v41, v41 quad_perm:[1,0,3,2] row_mask:0xf bank_mask:0xf
    v_add_f32_dpp v42, v42, v42 quad_perm:[1,0,3,2] row_mask:0xf bank_mask:0xf
    v_add_f32_dpp v40, v40, v40 quad_perm:[2,3,0,1] row_mask:0xf bank_mask:0xf
    v_add_f32_dpp v41, v41, v41 quad_perm:[2,3,0,1] row_mask:0xf bank_mask:0xf
    v_add_f32_dpp v42, v42, v42 quad_perm:[2,3,0,1] row_mask:0xf bank_mask:0xf
    v_add_f32_dpp v40, v40, v40 row_half_mirror row_mask:0xf bank_mask:0xf
    v_add_f32_dpp v41, v41, v41 row_half_mirror row_mask:0xf bank_mask:0xf
    v_add_f32_dpp v42, v42, v42 row_half_mirror row_mask:0xf bank_mask:0xf
    v_cvt_pk_bf16_f32 v40, v40, v40
    v_cvt_pk_bf16_f32 v41, v41, v41
    v_cvt_pk_bf16_f32 v42, v42, v42
    v_and_b32 v40, s55, v40
    v_and_b32 v41, s55, v41
    v_and_b32 v42, s55, v42
    v_mul_f32 v40, s56, v40
    v_mul_f32 v41, s56, v41
    v_mul_f32 v42, s56, v42
    v_cvt_pk_bf16_f32 v40, v40, v40
    v_cvt_pk_bf16_f32 v41, v41, v41
    v_cvt_pk_bf16_f32 v42, v42, v42
    v_and_b32 v40, s55, v40
    v_and_b32 v41, s55, v41
    v_and_b32 v42, s55, v42
    v_max_f32 v72, v72, v40
    v_max_f32 v72, v72, v41
    v_max_f32 v72, v72, v42
    s_waitcnt vmcnt(4)
    buffer_load_dwordx4 v[248:251], v1, s[28:31], s53 offen offset:128 nt
    v_dot2c_f32_bf16 v43, v112, v8
    v_dot2c_f32_bf16 v44, v124, v8
    v_dot2c_f32_bf16 v45, v136, v8
    v_dot2c_f32_bf16 v43, v113, v9
    v_dot2c_f32_bf16 v44, v125, v9
    v_dot2c_f32_bf16 v45, v137, v9
    v_dot2c_f32_bf16 v43, v114, v10
    v_dot2c_f32_bf16 v44, v126, v10
    v_dot2c_f32_bf16 v45, v138, v10
    v_dot2c_f32_bf16 v43, v115, v11
    v_dot2c_f32_bf16 v44, v127, v11
    v_dot2c_f32_bf16 v45, v139, v11
    v_dot2c_f32_bf16 v43, v116, v12
    v_dot2c_f32_bf16 v44, v128, v12
    v_dot2c_f32_bf16 v45, v140, v12
    v_dot2c_f32_bf16 v43, v117, v13
    v_dot2c_f32_bf16 v44, v129, v13
    v_dot2c_f32_bf16 v45, v141, v13
    v_dot2c_f32_bf16 v43, v118, v14
    v_dot2c_f32_bf16 v44, v130, v14
    v_dot2c_f32_bf16 v45, v142, v14
    v_dot2c_f32_bf16 v43, v119, v15
    v_dot2c_f32_bf16 v44, v131, v15
    v_dot2c_f32_bf16 v45, v143, v15
    v_dot2c_f32_bf16 v43, v120, v16
    v_dot2c_f32_bf16 v44, v132, v16
    v_dot2c_f32_bf16 v45, v144, v16
    v_dot2c_f32_bf16 v43, v121, v17
    v_dot2c_f32_bf16 v44, v133, v17
    v_dot2c_f32_bf16 v45, v145, v17
    v_dot2c_f32_bf16 v43, v122, v18
    v_dot2c_f32_bf16 v44, v134, v18
    v_dot2c_f32_bf16 v45, v146, v18
    v_dot2c_f32_bf16 v43, v123, v19
    v_dot2c_f32_bf16 v44, v135, v19
    v_dot2c_f32_bf16 v45, v147, v19
    s_nop 0
    v_add_f32_dpp v43, v43, v43 quad_perm:[1,0,3,2] row_mask:0xf bank_mask:0xf
    v_add_f32_dpp v44, v44, v44 quad_perm:[1,0,3,2] row_mask:0xf bank_mask:0xf
    v_add_f32_dpp v45, v45, v45 quad_perm:[1,0,3,2] row_mask:0xf bank_mask:0xf
    v_add_f32_dpp v43, v43, v43 quad_perm:[2,3,0,1] row_mask:0xf bank_mask:0xf
    v_add_f32_dpp v44, v44, v44 quad_perm:[2,3,0,1] row_mask:0xf bank_mask:0xf
    v_add_f32_dpp v45, v45, v45 quad_perm:[2,3,0,1] row_mask:0xf bank_mask:0xf
    v_add_f32_dpp v43, v43, v43 row_half_mirror row_mask:0xf bank_mask:0xf
    v_add_f32_dpp v44, v44, v44 row_half_mirror row_mask:0xf bank_mask:0xf
    v_add_f32_dpp v45, v45, v45 row_half_mirror row_mask:0xf bank_mask:0xf
    v_cvt_pk_bf16_f32 v43, v43, v43
    v_cvt_pk_bf16_f32 v44, v44, v44
    v_cvt_pk_bf16_f32 v45, v45, v45
    v_and_b32 v43, s55, v43
    v_and_b32 v44, s55, v44
    v_and_b32 v45, s55, v45
    v_mul_f32 v43, s56, v43
    v_mul_f32 v44, s56, v44
    v_mul_f32 v45, s56, v45
    v_cvt_pk_bf16_f32 v43, v43, v43
    v_cvt_pk_bf16_f32 v44, v44, v44
    v_cvt_pk_bf16_f32 v45, v45, v45
    v_and_b32 v43, s55, v43
    v_and_b32 v44, s55, v44
    v_and_b32 v45, s55, v45
    v_max_f32 v72, v72, v43
    v_max_f32 v72, v72, v44
    v_max_f32 v72, v72, v45
    s_waitcnt vmcnt(4)
    buffer_load_dwordx4 v[252:255], v1, s[28:31], s53 offen offset:256 nt
    s_add_u32 s53, s59, 480
    s_and_b32 s53, s53, 1023
    s_mul_i32 s53, s53, 3072
    s_add_u32 s53, s53, s60
    v_dot2c_f32_bf16 v46, v148, v8
    v_dot2c_f32_bf16 v47, v160, v8
    v_dot2c_f32_bf16 v48, v172, v8
    v_dot2c_f32_bf16 v46, v149, v9
    v_dot2c_f32_bf16 v47, v161, v9
    v_dot2c_f32_bf16 v48, v173, v9
    v_dot2c_f32_bf16 v46, v150, v10
    v_dot2c_f32_bf16 v47, v162, v10
    v_dot2c_f32_bf16 v48, v174, v10
    v_dot2c_f32_bf16 v46, v151, v11
    v_dot2c_f32_bf16 v47, v163, v11
    v_dot2c_f32_bf16 v48, v175, v11
    v_dot2c_f32_bf16 v46, v152, v12
    v_dot2c_f32_bf16 v47, v164, v12
    v_dot2c_f32_bf16 v48, v176, v12
    v_dot2c_f32_bf16 v46, v153, v13
    v_dot2c_f32_bf16 v47, v165, v13
    v_dot2c_f32_bf16 v48, v177, v13
    v_dot2c_f32_bf16 v46, v154, v14
    v_dot2c_f32_bf16 v47, v166, v14
    v_dot2c_f32_bf16 v48, v178, v14
    v_dot2c_f32_bf16 v46, v155, v15
    v_dot2c_f32_bf16 v47, v167, v15
    v_dot2c_f32_bf16 v48, v179, v15
    v_dot2c_f32_bf16 v46, v156, v16
    v_dot2c_f32_bf16 v47, v168, v16
    v_dot2c_f32_bf16 v48, v180, v16
    v_dot2c_f32_bf16 v46, v157, v17
    v_dot2c_f32_bf16 v47, v169, v17
    v_dot2c_f32_bf16 v48, v181, v17
    v_dot2c_f32_bf16 v46, v158, v18
    v_dot2c_f32_bf16 v47, v170, v18
    v_dot2c_f32_bf16 v48, v182, v18
    v_dot2c_f32_bf16 v46, v159, v19
    v_dot2c_f32_bf16 v47, v171, v19
    v_dot2c_f32_bf16 v48, v183, v19
    s_nop 0
    v_add_f32_dpp v46, v46, v46 quad_perm:[1,0,3,2] row_mask:0xf bank_mask:0xf
    v_add_f32_dpp v47, v47, v47 quad_perm:[1,0,3,2] row_mask:0xf bank_mask:0xf
    v_add_f32_dpp v48, v48, v48 quad_perm:[1,0,3,2] row_mask:0xf bank_mask:0xf
    v_add_f32_dpp v46, v46, v46 quad_perm:[2,3,0,1] row_mask:0xf bank_mask:0xf
    v_add_f32_dpp v47, v47, v47 quad_perm:[2,3,0,1] row_mask:0xf bank_mask:0xf
    v_add_f32_dpp v48, v48, v48 quad_perm:[2,3,0,1] row_mask:0xf bank_mask:0xf
    v_add_f32_dpp v46, v46, v46 row_half_mirror row_mask:0xf bank_mask:0xf
    v_add_f32_dpp v47, v47, v47 row_half_mirror row_mask:0xf bank_mask:0xf
    v_add_f32_dpp v48, v48, v48 row_half_mirror row_mask:0xf bank_mask:0xf
    v_cvt_pk_bf16_f32 v46, v46, v46
    v_cvt_pk_bf16_f32 v47, v47, v47
    v_cvt_pk_bf16_f32 v48, v48, v48
    v_and_b32 v46, s55, v46
    v_and_b32 v47, s55, v47
    v_and_b32 v48, s55, v48
    v_mul_f32 v46, s56, v46
    v_mul_f32 v47, s56, v47
    v_mul_f32 v48, s56, v48
    v_cvt_pk_bf16_f32 v46, v46, v46
    v_cvt_pk_bf16_f32 v47, v47, v47
    v_cvt_pk_bf16_f32 v48, v48, v48
    v_and_b32 v46, s55, v46
    v_and_b32 v47, s55, v47
    v_and_b32 v48, s55, v48
    v_max_f32 v72, v72, v46
    v_max_f32 v72, v72, v47
    v_max_f32 v72, v72, v48
    s_waitcnt vmcnt(4)
    buffer_load_dwordx4 v[76:79], v1, s[28:31], s53 offen offset:0 nt
    v_dot2c_f32_bf16 v49, v184, v8
    v_dot2c_f32_bf16 v50, v196, v8
    v_dot2c_f32_bf16 v51, v208, v8
    v_dot2c_f32_bf16 v49, v185, v9
    v_dot2c_f32_bf16 v50, v197, v9
    v_dot2c_f32_bf16 v51, v209, v9
    v_dot2c_f32_bf16 v49, v186, v10
    v_dot2c_f32_bf16 v50, v198, v10
    v_dot2c_f32_bf16 v51, v210, v10
    v_dot2c_f32_bf16 v49, v187, v11
    v_dot2c_f32_bf16 v50, v199, v11
    v_dot2c_f32_bf16 v51, v211, v11
    v_dot2c_f32_bf16 v49, v188, v12
    v_dot2c_f32_bf16 v50, v200, v12
    v_dot2c_f32_bf16 v51, v212, v12
    v_dot2c_f32_bf16 v49, v189, v13
    v_dot2c_f32_bf16 v50, v201, v13
    v_dot2c_f32_bf16 v51, v213, v13
    v_dot2c_f32_bf16 v49, v190, v14
    v_dot2c_f32_bf16 v50, v202, v14
    v_dot2c_f32_bf16 v51, v214, v14
    v_dot2c_f32_bf16 v49, v191, v15
    v_dot2c_f32_bf16 v50, v203, v15
    v_dot2c_f32_bf16 v51, v215, v15
    v_dot2c_f32_bf16 v49, v192, v16
    v_dot2c_f32_bf16 v50, v204, v16
    v_dot2c_f32_bf16 v51, v216, v16
    v_dot2c_f32_bf16 v49, v193, v17
    v_dot2c_f32_bf16 v50, v205, v17
    v_dot2c_f32_bf16 v51, v217, v17
    v_dot2c_f32_bf16 v49, v194, v18
    v_dot2c_f32_bf16 v50, v206, v18
    v_dot2c_f32_bf16 v51, v218, v18
    v_dot2c_f32_bf16 v49, v195, v19
    v_dot2c_f32_bf16 v50, v207, v19
    v_dot2c_f32_bf16 v51, v219, v19
    s_nop 0
    v_add_f32_dpp v49, v49, v49 quad_perm:[1,0,3,2] row_mask:0xf bank_mask:0xf
    v_add_f32_dpp v50, v50, v50 quad_perm:[1,0,3,2] row_mask:0xf bank_mask:0xf
    v_add_f32_dpp v51, v51, v51 quad_perm:[1,0,3,2] row_mask:0xf bank_mask:0xf
    v_add_f32_dpp v49, v49, v49 quad_perm:[2,3,0,1] row_mask:0xf bank_mask:0xf
    v_add_f32_dpp v50, v50, v50 quad_perm:[2,3,0,1] row_mask:0xf bank_mask:0xf
    v_add_f32_dpp v51, v51, v51 quad_perm:[2,3,0,1] row_mask:0xf bank_mask:0xf
    v_add_f32_dpp v49, v49, v49 row_half_mirror row_mask:0xf bank_mask:0xf
    v_add_f32_dpp v50, v50, v50 row_half_mirror row_mask:0xf bank_mask:0xf
    v_add_f32_dpp v51, v51, v51 row_half_mirror row_mask:0xf bank_mask:0xf
    v_cvt_pk_bf16_f32 v49, v49, v49
    v_cvt_pk_bf16_f32 v50, v50, v50
    v_cvt_pk_bf16_f32 v51, v51, v51
    v_and_b32 v49, s55, v49
    v_and_b32 v50, s55, v50
    v_and_b32 v51, s55, v51
    v_mul_f32 v49, s56, v49
    v_mul_f32 v50, s56, v50
    v_mul_f32 v51, s56, v51
    v_cvt_pk_bf16_f32 v49, v49, v49
    v_cvt_pk_bf16_f32 v50, v50, v50
    v_cvt_pk_bf16_f32 v51, v51, v51
    v_and_b32 v49, s55, v49
    v_and_b32 v50, s55, v50
    v_and_b32 v51, s55, v51
    v_max_f32 v72, v72, v49
    v_max_f32 v72, v72, v50
    v_max_f32 v72, v72, v51
    s_waitcnt vmcnt(4)
    buffer_load_dwordx4 v[80:83], v1, s[28:31], s53 offen offset:128 nt
    v_dot2c_f32_bf16 v52, v220, v8
    v_dot2c_f32_bf16 v53, v232, v8
    v_dot2c_f32_bf16 v52, v221, v9
    v_dot2c_f32_bf16 v53, v233, v9
    v_dot2c_f32_bf16 v52, v222, v10
    v_dot2c_f32_bf16 v53, v234, v10
    v_dot2c_f32_bf16 v52, v223, v11
    v_dot2c_f32_bf16 v53, v235, v11
    v_dot2c_f32_bf16 v52, v224, v12
    v_dot2c_f32_bf16 v53, v236, v12
    v_dot2c_f32_bf16 v52, v225, v13
    v_dot2c_f32_bf16 v53, v237, v13
    v_dot2c_f32_bf16 v52, v226, v14
    v_dot2c_f32_bf16 v53, v238, v14
    v_dot2c_f32_bf16 v52, v227, v15
    v_dot2c_f32_bf16 v53, v239, v15
    v_dot2c_f32_bf16 v52, v228, v16
    v_dot2c_f32_bf16 v53, v240, v16
    v_dot2c_f32_bf16 v52, v229, v17
    v_dot2c_f32_bf16 v53, v241, v17
    v_dot2c_f32_bf16 v52, v230, v18
    v_dot2c_f32_bf16 v53, v242, v18
    v_dot2c_f32_bf16 v52, v231, v19
    v_dot2c_f32_bf16 v53, v243, v19
    s_nop 1
    v_add_f32_dpp v52, v52, v52 quad_perm:[1,0,3,2] row_mask:0xf bank_mask:0xf
    v_add_f32_dpp v53, v53, v53 quad_perm:[1,0,3,2] row_mask:0xf bank_mask:0xf
    s_nop 0
    v_add_f32_dpp v52, v52, v52 quad_perm:[2,3,0,1] row_mask:0xf bank_mask:0xf
    v_add_f32_dpp v53, v53, v53 quad_perm:[2,3,0,1] row_mask:0xf bank_mask:0xf
    s_nop 0
    v_add_f32_dpp v52, v52, v52 row_half_mirror row_mask:0xf bank_mask:0xf
    v_add_f32_dpp v53, v53, v53 row_half_mirror row_mask:0xf bank_mask:0xf
    v_cvt_pk_bf16_f32 v52, v52, v52
    v_cvt_pk_bf16_f32 v53, v53, v53
    v_and_b32 v52, s55, v52
    v_and_b32 v53, s55, v53
    v_mul_f32 v52, s56, v52
    v_mul_f32 v53, s56, v53
    v_cvt_pk_bf16_f32 v52, v52, v52
    v_cvt_pk_bf16_f32 v53, v53, v53
    v_and_b32 v52, s55, v52
    v_and_b32 v53, s55, v53
    v_max_f32 v72, v72, v52
    v_max_f32 v72, v72, v53
    s_waitcnt vmcnt(4)
    buffer_load_dwordx4 v[84:87], v1, s[28:31], s53 offen offset:256 nt
    s_add_u32 s53, s59, 512
    s_and_b32 s53, s53, 1023
    s_mul_i32 s53, s53, 3072
    s_add_u32 s53, s53, s60
    s_waitcnt vmcnt(4)
    buffer_load_dwordx4 v[88:91], v1, s[28:31], s53 offen offset:0 nt
    s_waitcnt vmcnt(4)
    buffer_load_dwordx4 v[92:95], v1, s[28:31], s53 offen offset:128 nt
    v_dot2c_f32_bf16 v54, v244, v8
    v_dot2c_f32_bf16 v54, v245, v9
    v_dot2c_f32_bf16 v54, v246, v10
    v_dot2c_f32_bf16 v54, v247, v11
    v_dot2c_f32_bf16 v54, v248, v12
    v_dot2c_f32_bf16 v54, v249, v13
    v_dot2c_f32_bf16 v54, v250, v14
    v_dot2c_f32_bf16 v54, v251, v15
    v_dot2c_f32_bf16 v54, v252, v16
    v_dot2c_f32_bf16 v54, v253, v17
    v_dot2c_f32_bf16 v54, v254, v18
    v_dot2c_f32_bf16 v54, v255, v19
    s_nop 2
    v_add_f32_dpp v54, v54, v54 quad_perm:[1,0,3,2] row_mask:0xf bank_mask:0xf
    s_nop 1
    v_add_f32_dpp v54, v54, v54 quad_perm:[2,3,0,1] row_mask:0xf bank_mask:0xf
    s_nop 1
    v_add_f32_dpp v54, v54, v54 row_half_mirror row_mask:0xf bank_mask:0xf
    v_cvt_pk_bf16_f32 v54, v54, v54
    v_and_b32 v54, s55, v54
    v_mul_f32 v54, s56, v54
    v_cvt_pk_bf16_f32 v54, v54, v54
    v_and_b32 v54, s55, v54
    v_max_f32 v72, v72, v54
    s_waitcnt vmcnt(4)
    buffer_load_dwordx4 v[96:99], v1, s[28:31], s53 offen offset:256 nt
    s_add_u32 s53, s59, 544
    s_and_b32 s53, s53, 1023
    s_mul_i32 s53, s53, 3072
    s_add_u32 s53, s53, s60
    s_waitcnt vmcnt(4)
    buffer_load_dwordx4 v[100:103], v1, s[28:31], s53 offen offset:0 nt
    s_waitcnt vmcnt(4)
    buffer_load_dwordx4 v[104:107], v1, s[28:31], s53 offen offset:128 nt
    v_dot2c_f32_bf16 v55, v76, v8
    v_dot2c_f32_bf16 v55, v77, v9
    v_dot2c_f32_bf16 v55, v78, v10
    v_dot2c_f32_bf16 v55, v79, v11
    v_dot2c_f32_bf16 v55, v80, v12
    v_dot2c_f32_bf16 v55, v81, v13
    v_dot2c_f32_bf16 v55, v82, v14
    v_dot2c_f32_bf16 v55, v83, v15
    v_dot2c_f32_bf16 v55, v84, v16
    v_dot2c_f32_bf16 v55, v85, v17
    v_dot2c_f32_bf16 v55, v86, v18
    v_dot2c_f32_bf16 v55, v87, v19
    s_nop 2
    v_add_f32_dpp v55, v55, v55 quad_perm:[1,0,3,2] row_mask:0xf bank_mask:0xf
    s_nop 1
    v_add_f32_dpp v55, v55, v55 quad_perm:[2,3,0,1] row_mask:0xf bank_mask:0xf
    s_nop 1
    v_add_f32_dpp v55, v55, v55 row_half_mirror row_mask:0xf bank_mask:0xf
    v_cvt_pk_bf16_f32 v55, v55, v55
    v_and_b32 v55, s55, v55
    v_mul_f32 v55, s56, v55
    v_cvt_pk_bf16_f32 v55, v55, v55
    v_and_b32 v55, s55, v55
    v_max_f32 v72, v72, v55
    s_waitcnt vmcnt(4)
    buffer_load_dwordx4 v[108:111], v1, s[28:31], s53 offen offset:256 nt
    s_add_u32 s53, s59, 576
    s_and_b32 s53, s53, 1023
    s_mul_i32 s53, s53, 3072
    s_add_u32 s53, s53, s60
    s_mov_b32 s58, 1
    s_mov_b64 vcc, 0
    s_lshl_b32 s54, s3, 2
    v_mov_b32 v0, s54
    v_mov_b32 v2, 48
    ds_read_b32 v75, v0 offset:8720
    ds_write_b32 v0, v2 offset:8704
    s_waitcnt vmcnt(4)
    s_waitcnt vmcnt(5)
    s_cmp_eq_u32 s58, 2
    s_cbranch_scc1 L_i54
    s_waitcnt vmcnt(4)
    s_cbranch_vccz L_i54
    s_waitcnt vmcnt(4)
L_i54:
    buffer_load_dwordx4 v[112:115], v1, s[28:31], s53 offen offset:0 nt
    s_waitcnt vmcnt(6)
    s_cmp_eq_u32 s58, 2
    s_cbranch_scc1 L_i55
    s_waitcnt vmcnt(5)
    s_cbranch_vccz L_i55
    s_waitcnt vmcnt(4)
L_i55:
    buffer_load_dwordx4 v[116:119], v1, s[28:31], s53 offen offset:128 nt
    s_waitcnt vmcnt(5)
    s_cmp_eq_u32 s58, 2
    s_cbranch_scc1 L_i56
    s_waitcnt vmcnt(4)
    s_cbranch_vccz L_i56
    s_waitcnt vmcnt(4)
L_i56:
    buffer_load_dwordx4 v[120:123], v1, s[28:31], s53 offen offset:256 nt
    s_add_u32 s53, s59, 608
    s_and_b32 s53, s53, 1023
    s_mul_i32 s53, s53, 3072
    s_add_u32 s53, s53, s60
    s_waitcnt vmcnt(6)
    s_cmp_eq_u32 s58, 2
    s_cbranch_scc1 L_i57
    s_waitcnt vmcnt(5)
    s_cbranch_vccz L_i57
    s_waitcnt vmcnt(4)
L_i57:
    buffer_load_dwordx4 v[124:127], v1, s[28:31], s53 offen offset:0 nt
    s_waitcnt vmcnt(7)
    s_waitcnt vmcnt(5)
    s_cmp_eq_u32 s58, 2
    s_cbranch_scc1 L_i58
    s_waitcnt vmcnt(4)
    s_cbranch_vccz L_i58
    s_waitcnt vmcnt(4)
L_i58:
    buffer_load_dwordx4 v[128:131], v1, s[28:31], s53 offen offset:128 nt
    v_dot2c_f32_bf16 v56, v88, v8
    v_dot2c_f32_bf16 v56, v89, v9
    v_dot2c_f32_bf16 v56, v90, v10
    v_dot2c_f32_bf16 v56, v91, v11
    v_dot2c_f32_bf16 v56, v92, v12
    v_dot2c_f32_bf16 v56, v93, v13
    v_dot2c_f32_bf16 v56, v94, v14
    v_dot2c_f32_bf16 v56, v95, v15
    v_dot2c_f32_bf16 v56, v96, v16
    v_dot2c_f32_bf16 v56, v97, v17
    v_dot2c_f32_bf16 v56, v98, v18
    v_dot2c_f32_bf16 v56, v99, v19
    s_nop 2
    v_add_f32_dpp v56, v56, v56 quad_perm:[1,0,3,2] row_mask:0xf bank_mask:0xf
    s_nop 1
    v_add_f32_dpp v56, v56, v56 quad_perm:[2,3,0,1] row_mask:0xf bank_mask:0xf
    s_nop 1
    v_add_f32_dpp v56, v56, v56 row_half_mirror row_mask:0xf bank_mask:0xf
    v_cvt_pk_bf16_f32 v56, v56, v56
    v_and_b32 v56, s55, v56
    v_mul_f32 v56, s56, v56
    v_cvt_pk_bf16_f32 v56, v56, v56
    v_and_b32 v56, s55, v56
    v_max_f32 v72, v72, v56
    s_waitcnt vmcnt(7)
    s_waitcnt vmcnt(6)
    s_cmp_eq_u32 s58, 2
    s_cbranch_scc1 L_i59
    s_waitcnt vmcnt(5)
    s_cbranch_vccz L_i59
    s_waitcnt vmcnt(4)
L_i59:
    buffer_load_dwordx4 v[132:135], v1, s[28:31], s53 offen offset:256 nt
    s_add_u32 s53, s59, 640
    s_and_b32 s53, s53, 1023
    s_mul_i32 s53, s53, 3072
    s_add_u32 s53, s53, s60
    v_mov_b32 v2, 51
    ds_read_b32 v75, v0 offset:8720
    ds_write_b32 v0, v2 offset:8704
    s_waitcnt vmcnt(7)
    s_waitcnt vmcnt(5)
    s_cmp_eq_u32 s58, 2
    s_cbranch_scc1 L_i60
    s_waitcnt vmcnt(4)
    s_cbranch_vccz L_i60
    s_waitcnt vmcnt(4)
L_i60:
    buffer_load_dwordx4 v[136:139], v1, s[28:31], s53 offen offset:0 nt
    s_waitcnt lgkmcnt(0)
    v_readfirstlane_b32 s58, v75
    v_cmp_eq_u32 vcc, 0, v75
    s_waitcnt vmcnt(7)
    s_waitcnt vmcnt(6)
    s_cmp_eq_u32 s58, 2
    s_cbranch_scc1 L_i61
    s_waitcnt vmcnt(5)
    s_cbranch_vccz L_i61
    s_waitcnt vmcnt(4)
L_i61:
    buffer_load_dwordx4 v[140:143], v1, s[28:31], s53 offen offset:128 nt
    v_dot2c_f32_bf16 v57, v100, v8
    v_dot2c_f32_bf16 v57, v101, v9
    v_dot2c_f32_bf16 v57, v102, v10
    v_dot2c_f32_bf16 v57, v103, v11
    v_dot2c_f32_bf16 v57, v104, v12
    v_dot2c_f32_bf16 v57, v105, v13
    v_dot2c_f32_bf16 v57, v106, v14
    v_dot2c_f32_bf16 v57, v107, v15
    v_dot2c_f32_bf16 v57, v108, v16
    v_dot2c_f32_bf16 v57, v109, v17
    v_dot2c_f32_bf16 v57, v110, v18
    v_dot2c_f32_bf16 v57, v111, v19
    s_nop 2
    v_add_f32_dpp v57, v57, v57 quad_perm:[1,0,3,2] row_mask:0xf bank_mask:0xf
    s_nop 1
    v_add_f32_dpp v57, v57, v57 quad_perm:[2,3,0,1] row_mask:0xf bank_mask:0xf
    s_nop 1
    v_add_f32_dpp v57, v57, v57 row_half_mirror row_mask:0xf bank_mask:0xf
    v_cvt_pk_bf16_f32 v57, v57, v57
    v_and_b32 v57, s55, v57
    v_mul_f32 v57, s56, v57
    v_cvt_pk_bf16_f32 v57, v57, v57
    v_and_b32 v57, s55, v57
    v_max_f32 v72, v72, v57
    s_waitcnt vmcnt(7)
    s_waitcnt vmcnt(5)
    s_cmp_eq_u32 s58, 2
    s_cbranch_scc1 L_i62
    s_waitcnt vmcnt(4)
    s_cbranch_vccz L_i62
    s_waitcnt vmcnt(4)
L_i62:
    buffer_load_dwordx4 v[144:147], v1, s[28:31], s53 offen offset:256 nt
    s_add_u32 s53, s59, 672
    s_and_b32 s53, s53, 1023
    s_mul_i32 s53, s53, 3072
    s_add_u32 s53, s53, s60
    v_mov_b32 v2, 54
    ds_read_b32 v75, v0 offset:8720
    ds_write_b32 v0, v2 offset:8704
    s_waitcnt vmcnt(7)
    s_waitcnt vmcnt(6)
    s_cmp_eq_u32 s58, 2
    s_cbranch_scc1 L_i63
    s_waitcnt vmcnt(5)
    s_cbranch_vccz L_i63
    s_waitcnt vmcnt(4)
L_i63:
    buffer_load_dwordx4 v[148:151], v1, s[28:31], s53 offen offset:0 nt
    s_waitcnt lgkmcnt(0)
    v_readfirstlane_b32 s58, v75
    v_cmp_eq_u32 vcc, 0, v75
    s_waitcnt vmcnt(7)
    s_waitcnt vmcnt(5)
    s_cmp_eq_u32 s58, 2
    s_cbranch_scc1 L_i64
    s_waitcnt vmcnt(4)
    s_cbranch_vccz L_i64
    s_waitcnt vmcnt(4)
L_i64:
    buffer_load_dwordx4 v[152:155], v1, s[28:31], s53 offen offset:128 nt
    v_dot2c_f32_bf16 v58, v112, v8
    v_dot2c_f32_bf16 v58, v113, v9
    v_dot2c_f32_bf16 v58, v114, v10
    v_dot2c_f32_bf16 v58, v115, v11
    v_dot2c_f32_bf16 v58, v116, v12
    v_dot2c_f32_bf16 v58, v117, v13
    v_dot2c_f32_bf16 v58, v118, v14
    v_dot2c_f32_bf16 v58, v119, v15
    v_dot2c_f32_bf16 v58, v120, v16
    v_dot2c_f32_bf16 v58, v121, v17
    v_dot2c_f32_bf16 v58, v122, v18
    v_dot2c_f32_bf16 v58, v123, v19
    s_nop 2
    v_add_f32_dpp v58, v58, v58 quad_perm:[1,0,3,2] row_mask:0xf bank_mask:0xf
    s_nop 1
    v_add_f32_dpp v58, v58, v58 quad_perm:[2,3,0,1] row_mask:0xf bank_mask:0xf
    s_nop 1
    v_add_f32_dpp v58, v58, v58 row_half_mirror row_mask:0xf bank_mask:0xf
    v_cvt_pk_bf16_f32 v58, v58, v58
    v_and_b32 v58, s55, v58
    v_mul_f32 v58, s56, v58
    v_cvt_pk_bf16_f32 v58, v58, v58
    v_and_b32 v58, s55, v58
    v_max_f32 v72, v72, v58
    s_waitcnt vmcnt(7)
    s_waitcnt vmcnt(6)
    s_cmp_eq_u32 s58, 2
    s_cbranch_scc1 L_i65
    s_waitcnt vmcnt(5)
    s_cbranch_vccz L_i65
    s_waitcnt vmcnt(4)
L_i65:
    buffer_load_dwordx4 v[156:159], v1, s[28:31], s53 offen offset:256 nt
    s_add_u32 s53, s59, 704
    s_and_b32 s53, s53, 1023
    s_mul_i32 s53, s53, 3072
    s_add_u32 s53, s53, s60
    v_mov_b32 v2, 57
    ds_read_b32 v75, v0 offset:8720
    ds_write_b32 v0, v2 offset:8704
    s_waitcnt vmcnt(7)
    s_waitcnt vmcnt(5)
    s_cmp_eq_u32 s58, 2
    s_cbranch_scc1 L_i66
    s_waitcnt vmcnt(4)
    s_cbranch_vccz L_i66
    s_waitcnt vmcnt(4)
L_i66:
    buffer_load_dwordx4 v[160:163], v1, s[28:31], s53 offen offset:0 nt
    s_waitcnt lgkmcnt(0)
    v_readfirstlane_b32 s58, v75
    v_cmp_eq_u32 vcc, 0, v75
    s_waitcnt vmcnt(7)
    s_waitcnt vmcnt(6)
    s_cmp_eq_u32 s58, 2
    s_cbranch_scc1 L_i67
    s_waitcnt vmcnt(5)
    s_cbranch_vccz L_i67
    s_waitcnt vmcnt(4)
L_i67:
    buffer_load_dwordx4 v[164:167], v1, s[28:31], s53 offen offset:128 nt
    v_dot2c_f32_bf16 v59, v124, v8
    v_dot2c_f32_bf16 v59, v125, v9
    v_dot2c_f32_bf16 v59, v126, v10
    v_dot2c_f32_bf16 v59, v127, v11
    v_dot2c_f32_bf16 v59, v128, v12
    v_dot2c_f32_bf16 v59, v129, v13
    v_dot2c_f32_bf16 v59, v130, v14
    v_dot2c_f32_bf16 v59, v131, v15
    v_dot2c_f32_bf16 v59, v132, v16
    v_dot2c_f32_bf16 v59, v133, v17
    v_dot2c_f32_bf16 v59, v134, v18
    v_dot2c_f32_bf16 v59, v135, v19
    s_nop 2
    v_add_f32_dpp v59, v59, v59 quad_perm:[1,0,3,2] row_mask:0xf bank_mask:0xf
    s_nop 1
    v_add_f32_dpp v59, v59, v59 quad_perm:[2,3,0,1] row_mask:0xf bank_mask:0xf
    s_nop 1
    v_add_f32_dpp v59, v59, v59 row_half_mirror row_mask:0xf bank_mask:0xf
    v_cvt_pk_bf16_f32 v59, v59, v59
    v_and_b32 v59, s55, v59
    v_mul_f32 v59, s56, v59
    v_cvt_pk_bf16_f32 v59, v59, v59
    v_and_b32 v59, s55, v59
    v_max_f32 v72, v72, v59
    s_waitcnt vmcnt(7)
    s_waitcnt vmcnt(5)
    s_cmp_eq_u32 s58, 2
    s_cbranch_scc1 L_i68
    s_waitcnt vmcnt(4)
    s_cbranch_vccz L_i68
    s_waitcnt vmcnt(4)
L_i68:
    buffer_load_dwordx4 v[168:171], v1, s[28:31], s53 offen offset:256 nt
    s_add_u32 s53, s59, 736
    s_and_b32 s53, s53, 1023
    s_mul_i32 s53, s53, 3072
    s_add_u32 s53, s53, s60
    v_mov_b32 v2, 60
    ds_read_b32 v75, v0 offset:8720
    ds_write_b32 v0, v2 offset:8704
    s_waitcnt vmcnt(7)
    s_waitcnt vmcnt(6)
    s_cmp_eq_u32 s58, 2
    s_cbranch_scc1 L_i69
    s_waitcnt vmcnt(5)
    s_cbranch_vccz L_i69
    s_waitcnt vmcnt(4)
L_i69:
    buffer_load_dwordx4 v[172:175], v1, s[28:31], s53 offen offset:0 nt
    s_waitcnt lgkmcnt(0)
    v_readfirstlane_b32 s58, v75
    v_cmp_eq_u32 vcc, 0, v75
    s_waitcnt vmcnt(7)
    s_waitcnt vmcnt(5)
    s_cmp_eq_u32 s58, 2
    s_cbranch_scc1 L_i70
    s_waitcnt vmcnt(4)
    s_cbranch_vccz L_i70
    s_waitcnt vmcnt(4)
L_i70:
    buffer_load_dwordx4 v[176:179], v1, s[28:31], s53 offen offset:128 nt
    v_dot2c_f32_bf16 v60, v136, v8
    v_dot2c_f32_bf16 v60, v137, v9
    v_dot2c_f32_bf16 v60, v138, v10
    v_dot2c_f32_bf16 v60, v139, v11
    v_dot2c_f32_bf16 v60, v140, v12
    v_dot2c_f32_bf16 v60, v141, v13
    v_dot2c_f32_bf16 v60, v142, v14
    v_dot2c_f32_bf16 v60, v143, v15
    v_dot2c_f32_bf16 v60, v144, v16
    v_dot2c_f32_bf16 v60, v145, v17
    v_dot2c_f32_bf16 v60, v146, v18
    v_dot2c_f32_bf16 v60, v147, v19
    s_nop 2
    v_add_f32_dpp v60, v60, v60 quad_perm:[1,0,3,2] row_mask:0xf bank_mask:0xf
    s_nop 1
    v_add_f32_dpp v60, v60, v60 quad_perm:[2,3,0,1] row_mask:0xf bank_mask:0xf
    s_nop 1
    v_add_f32_dpp v60, v60, v60 row_half_mirror row_mask:0xf bank_mask:0xf
    v_cvt_pk_bf16_f32 v60, v60, v60
    v_and_b32 v60, s55, v60
    v_mul_f32 v60, s56, v60
    v_cvt_pk_bf16_f32 v60, v60, v60
    v_and_b32 v60, s55, v60
    v_max_f32 v72, v72, v60
    s_waitcnt vmcnt(7)
    s_waitcnt vmcnt(6)
    s_cmp_eq_u32 s58, 2
    s_cbranch_scc1 L_i71
    s_waitcnt vmcnt(5)
    s_cbranch_vccz L_i71
    s_waitcnt vmcnt(4)
L_i71:
    buffer_load_dwordx4 v[180:183], v1, s[28:31], s53 offen offset:256 nt
    s_add_u32 s53, s59, 768
    s_and_b32 s53, s53, 1023
    s_mul_i32 s53, s53, 3072
    s_add_u32 s53, s53, s60
    v_mov_b32 v2, 63
    ds_read_b32 v75, v0 offset:8720
    ds_write_b32 v0, v2 offset:8704
    s_waitcnt vmcnt(7)
    s_waitcnt vmcnt(5)
    s_cmp_eq_u32 s58, 2
    s_cbranch_scc1 L_i72
    s_waitcnt vmcnt(4)
    s_cbranch_vccz L_i72
    s_waitcnt vmcnt(4)
L_i72:
    buffer_load_dwordx4 v[184:187], v1, s[28:31], s53 offen offset:0 nt
    s_waitcnt lgkmcnt(0)
    v_readfirstlane_b32 s58, v75
    v_cmp_eq_u32 vcc, 0, v75
    s_waitcnt vmcnt(7)
    s_waitcnt vmcnt(6)
    s_cmp_eq_u32 s58, 2
    s_cbranch_scc1 L_i73
    s_waitcnt vmcnt(5)
    s_cbranch_vccz L_i73
    s_waitcnt vmcnt(4)
L_i73:
    buffer_load_dwordx4 v[188:191], v1, s[28:31], s53 offen offset:128 nt
    v_dot2c_f32_bf16 v61, v148, v8
    v_dot2c_f32_bf16 v61, v149, v9
    v_dot2c_f32_bf16 v61, v150, v10
    v_dot2c_f32_bf16 v61, v151, v11
    v_dot2c_f32_bf16 v61, v152, v12
    v_dot2c_f32_bf16 v61, v153, v13
    v_dot2c_f32_bf16 v61, v154, v14
    v_dot2c_f32_bf16 v61, v155, v15
    v_dot2c_f32_bf16 v61, v156, v16
    v_dot2c_f32_bf16 v61, v157, v17
    v_dot2c_f32_bf16 v61, v158, v18
    v_dot2c_f32_bf16 v61, v159, v19
    s_nop 2
    v_add_f32_dpp v61, v61, v61 quad_perm:[1,0,3,2] row_mask:0xf bank_mask:0xf
    s_nop 1
    v_add_f32_dpp v61, v61, v61 quad_perm:[2,3,0,1] row_mask:0xf bank_mask:0xf
    s_nop 1
    v_add_f32_dpp v61, v61, v61 row_half_mirror row_mask:0xf bank_mask:0xf
    v_cvt_pk_bf16_f32 v61, v61, v61
    v_and_b32 v61, s55, v61
    v_mul_f32 v61, s56, v61
    v_cvt_pk_bf16_f32 v61, v61, v61
    v_and_b32 v61, s55, v61
    v_max_f32 v72, v72, v61
    s_waitcnt vmcnt(7)
    s_waitcnt vmcnt(5)
    s_cmp_eq_u32 s58, 2
    s_cbranch_scc1 L_i74
    s_waitcnt vmcnt(4)
    s_cbranch_vccz L_i74
    s_waitcnt vmcnt(4)
L_i74:
    buffer_load_dwordx4 v[192:195], v1, s[28:31], s53 offen offset:256 nt
    s_add_u32 s53, s59, 800
    s_and_b32 s53, s53, 1023
    s_mul_i32 s53, s53, 3072
    s_add_u32 s53, s53, s60
    v_mov_b32 v2, 66
    ds_read_b32 v75, v0 offset:8720
    ds_write_b32 v0, v2 offset:8704
    s_waitcnt vmcnt(7)
    s_waitcnt vmcnt(6)
    s_cmp_eq_u32 s58, 2
    s_cbranch_scc1 L_i75
    s_waitcnt vmcnt(5)
    s_cbranch_vccz L_i75
    s_waitcnt vmcnt(4)
L_i75:
    buffer_load_dwordx4 v[196:199], v1, s[28:31], s53 offen offset:0 nt
    s_waitcnt lgkmcnt(0)
    v_readfirstlane_b32 s58, v75
    v_cmp_eq_u32 vcc, 0, v75
    s_waitcnt vmcnt(7)
    s_waitcnt vmcnt(5)
    s_cmp_eq_u32 s58, 2
    s_cbranch_scc1 L_i76
    s_waitcnt vmcnt(4)
    s_cbranch_vccz L_i76
    s_waitcnt vmcnt(4)
L_i76:
    buffer_load_dwordx4 v[200:203], v1, s[28:31], s53 offen offset:128 nt
    v_dot2c_f32_bf16 v62, v160, v8
    v_dot2c_f32_bf16 v62, v161, v9
    v_dot2c_f32_bf16 v62, v162, v10
    v_dot2c_f32_bf16 v62, v163, v11
    v_dot2c_f32_bf16 v62, v164, v12
    v_dot2c_f32_bf16 v62, v165, v13
    v_dot2c_f32_bf16 v62, v166, v14
    v_dot2c_f32_bf16 v62, v167, v15
    v_dot2c_f32_bf16 v62, v168, v16
    v_dot2c_f32_bf16 v62, v169, v17
    v_dot2c_f32_bf16 v62, v170, v18
    v_dot2c_f32_bf16 v62, v171, v19
    s_nop 2
    v_add_f32_dpp v62, v62, v62 quad_perm:[1,0,3,2] row_mask:0xf bank_mask:0xf
    s_nop 1
    v_add_f32_dpp v62, v62, v62 quad_perm:[2,3,0,1] row_mask:0xf bank_mask:0xf
    s_nop 1
    v_add_f32_dpp v62, v62, v62 row_half_mirror row_mask:0xf bank_mask:0xf
    v_cvt_pk_bf16_f32 v62, v62, v62
    v_and_b32 v62, s55, v62
    v_mul_f32 v62, s56, v62
    v_cvt_pk_bf16_f32 v62, v62, v62
    v_and_b32 v62, s55, v62
    v_max_f32 v72, v72, v62
    s_waitcnt vmcnt(7)
    s_waitcnt vmcnt(6)
    s_cmp_eq_u32 s58, 2
    s_cbranch_scc1 L_i77
    s_waitcnt vmcnt(5)
    s_cbranch_vccz L_i77
    s_waitcnt vmcnt(4)
L_i77:
    buffer_load_dwordx4 v[204:207], v1, s[28:31], s53 offen offset:256 nt
    s_add_u32 s53, s59, 832
    s_and_b32 s53, s53, 1023
    s_mul_i32 s53, s53, 3072
    s_add_u32 s53, s53, s60
    v_mov_b32 v2, 69
    ds_read_b32 v75, v0 offset:8720
    ds_write_b32 v0, v2 offset:8704
    s_waitcnt vmcnt(7)
    s_waitcnt vmcnt(5)
    s_cmp_eq_u32 s58, 2
    s_cbranch_scc1 L_i78
    s_waitcnt vmcnt(4)
    s_cbranch_vccz L_i78
    s_waitcnt vmcnt(4)
L_i78:
    buffer_load_dwordx4 v[208:211], v1, s[28:31], s53 offen offset:0 nt
    s_waitcnt lgkmcnt(0)
    v_readfirstlane_b32 s58, v75
    v_cmp_eq_u32 vcc, 0, v75
    s_waitcnt vmcnt(7)
    s_waitcnt vmcnt(6)
    s_cmp_eq_u32 s58, 2
    s_cbranch_scc1 L_i79
    s_waitcnt vmcnt(5)
    s_cbranch_vccz L_i79
    s_waitcnt vmcnt(4)
L_i79:
    buffer_load_dwordx4 v[212:215], v1, s[28:31], s53 offen offset:128 nt
    v_dot2c_f32_bf16 v63, v172, v8
    v_dot2c_f32_bf16 v63, v173, v9
    v_dot2c_f32_bf16 v63, v174, v10
    v_dot2c_f32_bf16 v63, v175, v11
    v_dot2c_f32_bf16 v63, v176, v12
    v_dot2c_f32_bf16 v63, v177, v13
    v_dot2c_f32_bf16 v63, v178, v14
    v_dot2c_f32_bf16 v63, v179, v15
    v_dot2c_f32_bf16 v63, v180, v16
    v_dot2c_f32_bf16 v63, v181, v17
    v_dot2c_f32_bf16 v63, v182, v18
    v_dot2c_f32_bf16 v63, v183, v19
    s_nop 2
    v_add_f32_dpp v63, v63, v63 quad_perm:[1,0,3,2] row_mask:0xf bank_mask:0xf
    s_nop 1
    v_add_f32_dpp v63, v63, v63 quad_perm:[2,3,0,1] row_mask:0xf bank_mask:0xf
    s_nop 1
    v_add_f32_dpp v63, v63, v63 row_half_mirror row_mask:0xf bank_mask:0xf
    v_cvt_pk_bf16_f32 v63, v63, v63
    v_and_b32 v63, s55, v63
    v_mul_f32 v63, s56, v63
    v_cvt_pk_bf16_f32 v63, v63, v63
    v_and_b32 v63, s55, v63
    v_max_f32 v72, v72, v63
    s_waitcnt vmcnt(7)
    s_waitcnt vmcnt(5)
    s_cmp_eq_u32 s58, 2
    s_cbranch_scc1 L_i80
    s_waitcnt vmcnt(4)
    s_cbranch_vccz L_i80
    s_waitcnt vmcnt(4)
L_i80:
    buffer_load_dwordx4 v[216:219], v1, s[28:31], s53 offen offset:256 nt
    s_add_u32 s53, s59, 864
    s_and_b32 s53, s53, 1023
    s_mul_i32 s53, s53, 3072
    s_add_u32 s53, s53, s60
    v_mov_b32 v2, 72
    ds_read_b32 v75, v0 offset:8720
    ds_write_b32 v0, v2 offset:8704
    s_waitcnt vmcnt(7)
    s_waitcnt vmcnt(6)
    s_cmp_eq_u32 s58, 2
    s_cbranch_scc1 L_i81
    s_waitcnt vmcnt(5)
    s_cbranch_vccz L_i81
    s_waitcnt vmcnt(4)
L_i81:
    buffer_load_dwordx4 v[220:223], v1, s[28:31], s53 offen offset:0 nt
    s_waitcnt lgkmcnt(0)
    v_readfirstlane_b32 s58, v75
    v_cmp_eq_u32 vcc, 0, v75
    s_waitcnt vmcnt(7)
    s_waitcnt vmcnt(5)
    s_cmp_eq_u32 s58, 2
    s_cbranch_scc1 L_i82
    s_waitcnt vmcnt(4)
    s_cbranch_vccz L_i82
    s_waitcnt vmcnt(4)
L_i82:
    buffer_load_dwordx4 v[224:227], v1, s[28:31], s53 offen offset:128 nt
    v_dot2c_f32_bf16 v64, v184, v8
    v_dot2c_f32_bf16 v64, v185, v9
    v_dot2c_f32_bf16 v64, v186, v10
    v_dot2c_f32_bf16 v64, v187, v11
    v_dot2c_f32_bf16 v64, v188, v12
    v_dot2c_f32_bf16 v64, v189, v13
    v_dot2c_f32_bf16 v64, v190, v14
    v_dot2c_f32_bf16 v64, v191, v15
    v_dot2c_f32_bf16 v64, v192, v16
    v_dot2c_f32_bf16 v64, v193, v17
    v_dot2c_f32_bf16 v64, v194, v18
    v_dot2c_f32_bf16 v64, v195, v19
    s_nop 2
    v_add_f32_dpp v64, v64, v64 quad_perm:[1,0,3,2] row_mask:0xf bank_mask:0xf
    s_nop 1
    v_add_f32_dpp v64, v64, v64 quad_perm:[2,3,0,1] row_mask:0xf bank_mask:0xf
    s_nop 1
    v_add_f32_dpp v64, v64, v64 row_half_mirror row_mask:0xf bank_mask:0xf
    v_cvt_pk_bf16_f32 v64, v64, v64
    v_and_b32 v64, s55, v64
    v_mul_f32 v64, s56, v64
    v_cvt_pk_bf16_f32 v64, v64, v64
    v_and_b32 v64, s55, v64
    v_max_f32 v72, v72, v64
    s_waitcnt vmcnt(7)
    s_waitcnt vmcnt(6)
    s_cmp_eq_u32 s58, 2
    s_cbranch_scc1 L_i83
    s_waitcnt vmcnt(5)
    s_cbranch_vccz L_i83
    s_waitcnt vmcnt(4)
L_i83:
    buffer_load_dwordx4 v[228:231], v1, s[28:31], s53 offen offset:256 nt
    s_add_u32 s53, s59, 896
    s_and_b32 s53, s53, 1023
    s_mul_i32 s53, s53, 3072
    s_add_u32 s53, s53, s60
    v_mov_b32 v2, 75
    ds_read_b32 v75, v0 offset:8720
    ds_write_b32 v0, v2 offset:8704
    s_waitcnt vmcnt(7)
    s_waitcnt vmcnt(5)
    s_cmp_eq_u32 s58, 2
    s_cbranch_scc1 L_i84
    s_waitcnt vmcnt(4)
    s_cbranch_vccz L_i84
    s_waitcnt vmcnt(4)
L_i84:
    buffer_load_dwordx4 v[232:235], v1, s[28:31], s53 offen offset:0 nt
    s_waitcnt lgkmcnt(0)
    v_readfirstlane_b32 s58, v75
    v_cmp_eq_u32 vcc, 0, v75
    s_waitcnt vmcnt(7)
    s_waitcnt vmcnt(6)
    s_cmp_eq_u32 s58, 2
    s_cbranch_scc1 L_i85
    s_waitcnt vmcnt(5)
    s_cbranch_vccz L_i85
    s_waitcnt vmcnt(4)
L_i85:
    buffer_load_dwordx4 v[236:239], v1, s[28:31], s53 offen offset:128 nt
    v_dot2c_f32_bf16 v65, v196, v8
    v_dot2c_f32_bf16 v65, v197, v9
    v_dot2c_f32_bf16 v65, v198, v10
    v_dot2c_f32_bf16 v65, v199, v11
    v_dot2c_f32_bf16 v65, v200, v12
    v_dot2c_f32_bf16 v65, v201, v13
    v_dot2c_f32_bf16 v65, v202, v14
    v_dot2c_f32_bf16 v65, v203, v15
    v_dot2c_f32_bf16 v65, v204, v16
    v_dot2c_f32_bf16 v65, v205, v17
    v_dot2c_f32_bf16 v65, v206, v18
    v_dot2c_f32_bf16 v65, v207, v19
    s_nop 2
    v_add_f32_dpp v65, v65, v65 quad_perm:[1,0,3,2] row_mask:0xf bank_mask:0xf
    s_nop 1
    v_add_f32_dpp v65, v65, v65 quad_perm:[2,3,0,1] row_mask:0xf bank_mask:0xf
    s_nop 1
    v_add_f32_dpp v65, v65, v65 row_half_mirror row_mask:0xf bank_mask:0xf
    v_cvt_pk_bf16_f32 v65, v65, v65
    v_and_b32 v65, s55, v65
    v_mul_f32 v65, s56, v65
    v_cvt_pk_bf16_f32 v65, v65, v65
    v_and_b32 v65, s55, v65
    v_max_f32 v72, v72, v65
    s_waitcnt vmcnt(7)
    s_waitcnt vmcnt(5)
    s_cmp_eq_u32 s58, 2
    s_cbranch_scc1 L_i86
    s_waitcnt vmcnt(4)
    s_cbranch_vccz L_i86
    s_waitcnt vmcnt(4)
L_i86:
    buffer_load_dwordx4 v[240:243], v1, s[28:31], s53 offen offset:256 nt
    s_add_u32 s53, s59, 928
    s_and_b32 s53, s53, 1023
    s_mul_i32 s53, s53, 3072
    s_add_u32 s53, s53, s60
    v_mov_b32 v2, 78
    ds_read_b32 v75, v0 offset:8720
    ds_write_b32 v0, v2 offset:8704
    s_waitcnt vmcnt(7)
    s_waitcnt vmcnt(6)
    s_cmp_eq_u32 s58, 2
    s_cbranch_scc1 L_i87
    s_waitcnt vmcnt(5)
    s_cbranch_vccz L_i87
    s_waitcnt vmcnt(4)
L_i87:
    buffer_load_dwordx4 v[244:247], v1, s[28:31], s53 offen offset:0 nt
    s_waitcnt lgkmcnt(0)
    v_readfirstlane_b32 s58, v75
    v_cmp_eq_u32 vcc, 0, v75
    s_waitcnt vmcnt(7)
    s_waitcnt vmcnt(5)
    s_cmp_eq_u32 s58, 2
    s_cbranch_scc1 L_i88
    s_waitcnt vmcnt(4)
    s_cbranch_vccz L_i88
    s_waitcnt vmcnt(4)
L_i88:
    buffer_load_dwordx4 v[248:251], v1, s[28:31], s53 offen offset:128 nt
    v_dot2c_f32_bf16 v66, v208, v8
    v_dot2c_f32_bf16 v66, v209, v9
    v_dot2c_f32_bf16 v66, v210, v10
    v_dot2c_f32_bf16 v66, v211, v11
    v_dot2c_f32_bf16 v66, v212, v12
    v_dot2c_f32_bf16 v66, v213, v13
    v_dot2c_f32_bf16 v66, v214, v14
    v_dot2c_f32_bf16 v66, v215, v15
    v_dot2c_f32_bf16 v66, v216, v16
    v_dot2c_f32_bf16 v66, v217, v17
    v_dot2c_f32_bf16 v66, v218, v18
    v_dot2c_f32_bf16 v66, v219, v19
    s_nop 2
    v_add_f32_dpp v66, v66, v66 quad_perm:[1,0,3,2] row_mask:0xf bank_mask:0xf
    s_nop 1
    v_add_f32_dpp v66, v66, v66 quad_perm:[2,3,0,1] row_mask:0xf bank_mask:0xf
    s_nop 1
    v_add_f32_dpp v66, v66, v66 row_half_mirror row_mask:0xf bank_mask:0xf
    v_cvt_pk_bf16_f32 v66, v66, v66
    v_and_b32 v66, s55, v66
    v_mul_f32 v66, s56, v66
    v_cvt_pk_bf16_f32 v66, v66, v66
    v_and_b32 v66, s55, v66
    v_max_f32 v72, v72, v66
    s_waitcnt vmcnt(7)
    s_waitcnt vmcnt(6)
    s_cmp_eq_u32 s58, 2
    s_cbranch_scc1 L_i89
    s_waitcnt vmcnt(5)
    s_cbranch_vccz L_i89
    s_waitcnt vmcnt(4)
L_i89:
    buffer_load_dwordx4 v[252:255], v1, s[28:31], s53 offen offset:256 nt
    s_add_u32 s53, s59, 960
    s_and_b32 s53, s53, 1023
    s_mul_i32 s53, s53, 3072
    s_add_u32 s53, s53, s60
    v_mov_b32 v2, 81
    ds_read_b32 v75, v0 offset:8720
    ds_write_b32 v0, v2 offset:8704
    s_waitcnt vmcnt(7)
    s_waitcnt vmcnt(5)
    s_cmp_eq_u32 s58, 2
    s_cbranch_scc1 L_i90
    s_waitcnt vmcnt(4)
    s_cbranch_vccz L_i90
    s_waitcnt vmcnt(4)
L_i90:
    buffer_load_dwordx4 v[76:79], v1, s[28:31], s53 offen offset:0 nt
    s_waitcnt lgkmcnt(0)
    v_readfirstlane_b32 s58, v75
    v_cmp_eq_u32 vcc, 0, v75
    s_waitcnt vmcnt(7)
    s_waitcnt vmcnt(6)
    s_cmp_eq_u32 s58, 2
    s_cbranch_scc1 L_i91
    s_waitcnt vmcnt(5)
    s_cbranch_vccz L_i91
    s_waitcnt vmcnt(4)
L_i91:
    buffer_load_dwordx4 v[80:83], v1, s[28:31], s53 offen offset:128 nt
    v_dot2c_f32_bf16 v67, v220, v8
    v_dot2c_f32_bf16 v67, v221, v9
    v_dot2c_f32_bf16 v67, v222, v10
    v_dot2c_f32_bf16 v67, v223, v11
    v_dot2c_f32_bf16 v67, v224, v12
    v_dot2c_f32_bf16 v67, v225, v13
    v_dot2c_f32_bf16 v67, v226, v14
    v_dot2c_f32_bf16 v67, v227, v15
    v_dot2c_f32_bf16 v67, v228, v16
    v_dot2c_f32_bf16 v67, v229, v17
    v_dot2c_f32_bf16 v67, v230, v18
    v_dot2c_f32_bf16 v67, v231, v19
    s_nop 2
    v_add_f32_dpp v67, v67, v67 quad_perm:[1,0,3,2] row_mask:0xf bank_mask:0xf
    s_nop 1
    v_add_f32_dpp v67, v67, v67 quad_perm:[2,3,0,1] row_mask:0xf bank_mask:0xf
    s_nop 1
    v_add_f32_dpp v67, v67, v67 row_half_mirror row_mask:0xf bank_mask:0xf
    v_cvt_pk_bf16_f32 v67, v67, v67
    v_and_b32 v67, s55, v67
    v_mul_f32 v67, s56, v67
    v_cvt_pk_bf16_f32 v67, v67, v67
    v_and_b32 v67, s55, v67
    v_max_f32 v72, v72, v67
    s_waitcnt vmcnt(7)
    s_waitcnt vmcnt(5)
    s_cmp_eq_u32 s58, 2
    s_cbranch_scc1 L_i92
    s_waitcnt vmcnt(4)
    s_cbranch_vccz L_i92
    s_waitcnt vmcnt(4)
L_i92:
    buffer_load_dwordx4 v[84:87], v1, s[28:31], s53 offen offset:256 nt
    s_add_u32 s53, s59, 992
    s_and_b32 s53, s53, 1023
    s_mul_i32 s53, s53, 3072
    s_add_u32 s53, s53, s60
    v_mov_b32 v2, 84
    ds_read_b32 v75, v0 offset:8720
    ds_write_b32 v0, v2 offset:8704
    s_waitcnt vmcnt(7)
    s_waitcnt vmcnt(6)
    s_cmp_eq_u32 s58, 2
    s_cbranch_scc1 L_i93
    s_waitcnt vmcnt(5)
    s_cbranch_vccz L_i93
    s_waitcnt vmcnt(4)
L_i93:
    buffer_load_dwordx4 v[88:91], v1, s[28:31], s53 offen offset:0 nt
    s_waitcnt lgkmcnt(0)
    v_readfirstlane_b32 s58, v75
    v_cmp_eq_u32 vcc, 0, v75
    s_waitcnt vmcnt(7)
    s_waitcnt vmcnt(5)
    s_cmp_eq_u32 s58, 2
    s_cbranch_scc1 L_i94
    s_waitcnt vmcnt(4)
    s_cbranch_vccz L_i94
    s_waitcnt vmcnt(4)
L_i94:
    buffer_load_dwordx4 v[92:95], v1, s[28:31], s53 offen offset:128 nt
    v_dot2c_f32_bf16 v68, v232, v8
    v_dot2c_f32_bf16 v68, v233, v9
    v_dot2c_f32_bf16 v68, v234, v10
    v_dot2c_f32_bf16 v68, v235, v11
    v_dot2c_f32_bf16 v68, v236, v12
    v_dot2c_f32_bf16 v68, v237, v13
    v_dot2c_f32_bf16 v68, v238, v14
    v_dot2c_f32_bf16 v68, v239, v15
    v_dot2c_f32_bf16 v68, v240, v16
    v_dot2c_f32_bf16 v68, v241, v17
    v_dot2c_f32_bf16 v68, v242, v18
    v_dot2c_f32_bf16 v68, v243, v19
    s_nop 2
    v_add_f32_dpp v68, v68, v68 quad_perm:[1,0,3,2] row_mask:0xf bank_mask:0xf
    s_nop 1
    v_add_f32_dpp v68, v68, v68 quad_perm:[2,3,0,1] row_mask:0xf bank_mask:0xf
    s_nop 1
    v_add_f32_dpp v68, v68, v68 row_half_mirror row_mask:0xf bank_mask:0xf
    v_cvt_pk_bf16_f32 v68, v68, v68
    v_and_b32 v68, s55, v68
    v_mul_f32 v68, s56, v68
    v_cvt_pk_bf16_f32 v68, v68, v68
    v_and_b32 v68, s55, v68
    v_max_f32 v72, v72, v68
    s_waitcnt vmcnt(7)
    s_waitcnt vmcnt(6)
    s_cmp_eq_u32 s58, 2
    s_cbranch_scc1 L_i95
    s_waitcnt vmcnt(5)
    s_cbranch_vccz L_i95
    s_waitcnt vmcnt(4)
L_i95:
    buffer_load_dwordx4 v[96:99], v1, s[28:31], s53 offen offset:256 nt
    s_add_u32 s53, s59, 0
    s_and_b32 s53, s53, 1023
    s_mul_i32 s53, s53, 3072
    s_add_u32 s53, s53, s60
    v_mov_b32 v2, 87
    ds_read_b32 v75, v0 offset:8720
    ds_write_b32 v0, v2 offset:8704
    s_waitcnt vmcnt(7)
    s_waitcnt vmcnt(6)
    s_cmp_eq_u32 s58, 2
    s_cbranch_scc1 L_i96
    s_waitcnt vmcnt(4)
    s_cbranch_vccz L_i96
    s_waitcnt vmcnt(4)
L_i96:
    buffer_load_dwordx4 v[100:103], v1, s[32:35], s53 offen offset:0 nt
    s_waitcnt lgkmcnt(0)
    v_readfirstlane_b32 s58, v75
    v_cmp_eq_u32 vcc, 0, v75
    s_waitcnt vmcnt(7)
    s_waitcnt vmcnt(6)
    s_cmp_eq_u32 s58, 2
    s_cbranch_scc1 L_i97
    s_waitcnt vmcnt(5)
    s_cbranch_vccz L_i97
    s_waitcnt vmcnt(4)
L_i97:
    buffer_load_dwordx4 v[104:107], v1, s[32:35], s53 offen offset:128 nt
    v_dot2c_f32_bf16 v69, v244, v8
    v_dot2c_f32_bf16 v69, v245, v9
    v_dot2c_f32_bf16 v69, v246, v10
    v_dot2c_f32_bf16 v69, v247, v11
    v_dot2c_f32_bf16 v69, v248, v12
    v_dot2c_f32_bf16 v69, v249, v13
    v_dot2c_f32_bf16 v69, v250, v14
    v_dot2c_f32_bf16 v69, v251, v15
    v_dot2c_f32_bf16 v69, v252, v16
    v_dot2c_f32_bf16 v69, v253, v17
    v_dot2c_f32_bf16 v69, v254, v18
    v_dot2c_f32_bf16 v69, v255, v19
    s_nop 2
    v_add_f32_dpp v69, v69, v69 quad_perm:[1,0,3,2] row_mask:0xf bank_mask:0xf
    s_nop 1
    v_add_f32_dpp v69, v69, v69 quad_perm:[2,3,0,1] row_mask:0xf bank_mask:0xf
    s_nop 1
    v_add_f32_dpp v69, v69, v69 row_half_mirror row_mask:0xf bank_mask:0xf
    v_cvt_pk_bf16_f32 v69, v69, v69
    v_and_b32 v69, s55, v69
    v_mul_f32 v69, s56, v69
    v_cvt_pk_bf16_f32 v69, v69, v69
    v_and_b32 v69, s55, v69
    v_max_f32 v72, v72, v69
    s_waitcnt vmcnt(7)
    s_waitcnt vmcnt(6)
    s_cmp_eq_u32 s58, 2
    s_cbranch_scc1 L_i98
    s_waitcnt vmcnt(4)
    s_cbranch_vccz L_i98
    s_waitcnt vmcnt(4)
L_i98:
    buffer_load_dwordx4 v[108:111], v1, s[32:35], s53 offen offset:256 nt
    s_add_u32 s53, s59, 32
    s_and_b32 s53, s53, 1023
    s_mul_i32 s53, s53, 3072
    s_add_u32 s53, s53, s60
    v_mov_b32 v2, 90
    ds_read_b32 v75, v0 offset:8720
    ds_write_b32 v0, v2 offset:8704
    s_waitcnt vmcnt(7)
    s_waitcnt vmcnt(6)
    s_cmp_eq_u32 s58, 2
    s_cbranch_scc1 L_i99
    s_waitcnt vmcnt(5)
    s_cbranch_vccz L_i99
    s_waitcnt vmcnt(4)
L_i99:
    buffer_load_dwordx4 v[112:115], v1, s[32:35], s53 offen offset:0 nt
    s_waitcnt lgkmcnt(0)
    v_readfirstlane_b32 s58, v75
    v_cmp_eq_u32 vcc, 0, v75
    s_waitcnt vmcnt(7)
    s_waitcnt vmcnt(6)
    s_cmp_eq_u32 s58, 2
    s_cbranch_scc1 L_i100
    s_waitcnt vmcnt(4)
    s_cbranch_vccz L_i100
    s_waitcnt vmcnt(4)
L_i100:
    buffer_load_dwordx4 v[116:119], v1, s[32:35], s53 offen offset:128 nt
    v_dot2c_f32_bf16 v70, v76, v8
    v_dot2c_f32_bf16 v70, v77, v9
    v_dot2c_f32_bf16 v70, v78, v10
    v_dot2c_f32_bf16 v70, v79, v11
    v_dot2c_f32_bf16 v70, v80, v12
    v_dot2c_f32_bf16 v70, v81, v13
    v_dot2c_f32_bf16 v70, v82, v14
    v_dot2c_f32_bf16 v70, v83, v15
    v_dot2c_f32_bf16 v70, v84, v16
    v_dot2c_f32_bf16 v70, v85, v17
    v_dot2c_f32_bf16 v70, v86, v18
    v_dot2c_f32_bf16 v70, v87, v19
    s_nop 2
    v_add_f32_dpp v70, v70, v70 quad_perm:[1,0,3,2] row_mask:0xf bank_mask:0xf
    s_nop 1
    v_add_f32_dpp v70, v70, v70 quad_perm:[2,3,0,1] row_mask:0xf bank_mask:0xf
    s_nop 1
    v_add_f32_dpp v70, v70, v70 row_half_mirror row_mask:0xf bank_mask:0xf
    v_cvt_pk_bf16_f32 v70, v70, v70
    v_and_b32 v70, s55, v70
    v_mul_f32 v70, s56, v70
    v_cvt_pk_bf16_f32 v70, v70, v70
    v_and_b32 v70, s55, v70
    v_max_f32 v72, v72, v70
    s_waitcnt vmcnt(7)
    s_waitcnt vmcnt(6)
    s_cmp_eq_u32 s58, 2
    s_cbranch_scc1 L_i101
    s_waitcnt vmcnt(5)
    s_cbranch_vccz L_i101
    s_waitcnt vmcnt(4)
L_i101:
    buffer_load_dwordx4 v[120:123], v1, s[32:35], s53 offen offset:256 nt
    s_add_u32 s53, s59, 64
    s_and_b32 s53, s53, 1023
    s_mul_i32 s53, s53, 3072
    s_add_u32 s53, s53, s60
    v_mov_b32 v2, 93
    ds_read_b32 v75, v0 offset:8720
    ds_write_b32 v0, v2 offset:8704
    s_waitcnt vmcnt(7)
    s_waitcnt vmcnt(6)
    s_cmp_eq_u32 s58, 2
    s_cbranch_scc1 L_i102
    s_waitcnt vmcnt(4)
    s_cbranch_vccz L_i102
    s_waitcnt vmcnt(4)
L_i102:
    buffer_load_dwordx4 v[124:127], v1, s[32:35], s53 offen offset:0 nt
    s_waitcnt lgkmcnt(0)
    v_readfirstlane_b32 s58, v75
    v_cmp_eq_u32 vcc, 0, v75
    s_waitcnt vmcnt(7)
    s_waitcnt vmcnt(6)
    s_cmp_eq_u32 s58, 2
    s_cbranch_scc1 L_i103
    s_waitcnt vmcnt(5)
    s_cbranch_vccz L_i103
    s_waitcnt vmcnt(4)
L_i103:
    buffer_load_dwordx4 v[128:131], v1, s[32:35], s53 offen offset:128 nt
    v_dot2c_f32_bf16 v71, v88, v8
    v_dot2c_f32_bf16 v71, v89, v9
    v_dot2c_f32_bf16 v71, v90, v10
    v_dot2c_f32_bf16 v71, v91, v11
    v_dot2c_f32_bf16 v71, v92, v12
    v_dot2c_f32_bf16 v71, v93, v13
    v_dot2c_f32_bf16 v71, v94, v14
    v_dot2c_f32_bf16 v71, v95, v15
    v_dot2c_f32_bf16 v71, v96, v16
    v_dot2c_f32_bf16 v71, v97, v17
    v_dot2c_f32_bf16 v71, v98, v18
    v_dot2c_f32_bf16 v71, v99, v19
    s_nop 2
    v_add_f32_dpp v71, v71, v71 quad_perm:[1,0,3,2] row_mask:0xf bank_mask:0xf
    s_nop 1
    v_add_f32_dpp v71, v71, v71 quad_perm:[2,3,0,1] row_mask:0xf bank_mask:0xf
    s_nop 1
    v_add_f32_dpp v71, v71, v71 row_half_mirror row_mask:0xf bank_mask:0xf
    v_cvt_pk_bf16_f32 v71, v71, v71
    v_and_b32 v71, s55, v71
    v_mul_f32 v71, s56, v71
    v_cvt_pk_bf16_f32 v71, v71, v71
    v_and_b32 v71, s55, v71
    v_max_f32 v72, v72, v71
    s_nop 1
    v_max_f32_dpp v72, v72, v72 row_ror:8 row_mask:0xf bank_mask:0xf
    v_mov_b32 v74, v72
    s_nop 1
    v_permlane16_swap_b32 v72, v74
    v_max_f32 v72, v72, v74
    v_mov_b32 v74, v72
    s_nop 1
    v_permlane32_swap_b32 v72, v74
    v_max_f32 v72, v72, v74
    v_mul_f32 v72, s57, v72
    s_waitcnt vmcnt(7)
    s_waitcnt vmcnt(6)
    s_cmp_eq_u32 s58, 2
    s_cbranch_scc1 L_i104
    s_waitcnt vmcnt(4)
    s_cbranch_vccz L_i104
    s_waitcnt vmcnt(4)
L_i104:
    buffer_load_dwordx4 v[132:135], v1, s[32:35], s53 offen offset:256 nt
    s_add_u32 s53, s59, 96
    s_and_b32 s53, s53, 1023
    s_mul_i32 s53, s53, 3072
    s_add_u32 s53, s53, s60
    v_mov_b32 v2, 96
    ds_read_b32 v75, v0 offset:8720
    ds_write_b32 v0, v2 offset:8704
    v_fma_f32 v40, v40, s57, -v72
    v_fma_f32 v41, v41, s57, -v72
    v_fma_f32 v42, v42, s57, -v72
    v_fma_f32 v43, v43, s57, -v72
    v_fma_f32 v44, v44, s57, -v72
    v_fma_f32 v45, v45, s57, -v72
    v_fma_f32 v46, v46, s57, -v72
    v_fma_f32 v47, v47, s57, -v72
    v_exp_f32 v40, v40
    v_exp_f32 v41, v41
    v_exp_f32 v42, v42
    v_exp_f32 v43, v43
    v_exp_f32 v44, v44
    v_exp_f32 v45, v45
    v_exp_f32 v46, v46
    v_exp_f32 v47, v47
    v_add_f32 v73, v40, v41
    v_add_f32 v73, v73, v42
    v_add_f32 v73, v73, v43
    v_add_f32 v73, v73, v44
    v_add_f32 v73, v73, v45
    v_add_f32 v73, v73, v46
    v_add_f32 v73, v73, v47
    s_waitcnt vmcnt(7)
    s_waitcnt vmcnt(6)
    s_cmp_eq_u32 s58, 2
    s_cbranch_scc1 L_i105
    s_waitcnt vmcnt(5)
    s_cbranch_vccz L_i105
    s_waitcnt vmcnt(4)
L_i105:
    buffer_load_dwordx4 v[136:139], v1, s[32:35], s53 offen offset:0 nt
    s_waitcnt lgkmcnt(0)
    v_readfirstlane_b32 s58, v75
    v_cmp_eq_u32 vcc, 0, v75
    v_fma_f32 v48, v48, s57, -v72
    v_fma_f32 v49, v49, s57, -v72
    v_fma_f32 v50, v50, s57, -v72
    v_fma_f32 v51, v51, s57, -v72
    v_fma_f32 v52, v52, s57, -v72
    v_fma_f32 v53, v53, s57, -v72
    v_fma_f32 v54, v54, s57, -v72
    v_fma_f32 v55, v55, s57, -v72
    v_exp_f32 v48, v48
    v_exp_f32 v49, v49
    v_exp_f32 v50, v50
    v_exp_f32 v51, v51
    v_exp_f32 v52, v52
    v_exp_f32 v53, v53
    v_exp_f32 v54, v54
    v_exp_f32 v55, v55
    v_add_f32 v73, v73, v48
    v_add_f32 v73, v73, v49
    v_add_f32 v73, v73, v50
    v_add_f32 v73, v73, v51
    v_add_f32 v73, v73, v52
    v_add_f32 v73, v73, v53
    v_add_f32 v73, v73, v54
    v_add_f32 v73, v73, v55
    s_waitcnt vmcnt(7)
    s_waitcnt vmcnt(6)
    s_cmp_eq_u32 s58, 2
    s_cbranch_scc1 L_i106
    s_waitcnt vmcnt(4)
    s_cbranch_vccz L_i106
    s_waitcnt vmcnt(4)
L_i106:
    buffer_load_dwordx4 v[140:143], v1, s[32:35], s53 offen offset:128 nt
    v_fma_f32 v56, v56, s57, -v72
    v_fma_f32 v57, v57, s57, -v72
    v_fma_f32 v58, v58, s57, -v72
    v_fma_f32 v59, v59, s57, -v72
    v_fma_f32 v60, v60, s57, -v72
    v_fma_f32 v61, v61, s57, -v72
    v_fma_f32 v62, v62, s57, -v72
    v_fma_f32 v63, v63, s57, -v72
    v_exp_f32 v56, v56
    v_exp_f32 v57, v57
    v_exp_f32 v58, v58
    v_exp_f32 v59, v59
    v_exp_f32 v60, v60
    v_exp_f32 v61, v61
    v_exp_f32 v62, v62
    v_exp_f32 v63, v63
    v_add_f32 v73, v73, v56
    v_add_f32 v73, v73, v57
    v_add_f32 v73, v73, v58
    v_add_f32 v73, v73, v59
    v_add_f32 v73, v73, v60
    v_add_f32 v73, v73, v61
    v_add_f32 v73, v73, v62
    v_add_f32 v73, v73, v63
    s_waitcnt vmcnt(7)
    s_waitcnt vmcnt(6)
    s_cmp_eq_u32 s58, 2
    s_cbranch_scc1 L_i107
    s_waitcnt vmcnt(5)
    s_cbranch_vccz L_i107
    s_waitcnt vmcnt(4)
L_i107:
    buffer_load_dwordx4 v[144:147], v1, s[32:35], s53 offen offset:256 nt
    s_add_u32 s53, s59, 128
    s_and_b32 s53, s53, 1023
    s_mul_i32 s53, s53, 3072
    s_add_u32 s53, s53, s60
    v_mov_b32 v2, 99
    ds_read_b32 v75, v0 offset:8720
    ds_write_b32 v0, v2 offset:8704
    v_fma_f32 v64, v64, s57, -v72
    v_fma_f32 v65, v65, s57, -v72
    v_fma_f32 v66, v66, s57, -v72
    v_fma_f32 v67, v67, s57, -v72
    v_fma_f32 v68, v68, s57, -v72
    v_fma_f32 v69, v69, s57, -v72
    v_fma_f32 v70, v70, s57, -v72
    v_fma_f32 v71, v71, s57, -v72
    v_exp_f32 v64, v64
    v_exp_f32 v65, v65
    v_exp_f32 v66, v66
    v_exp_f32 v67, v67
    v_exp_f32 v68, v68
    v_exp_f32 v69, v69
    v_exp_f32 v70, v70
    v_exp_f32 v71, v71
    v_add_f32 v73, v73, v64
    v_add_f32 v73, v73, v65
    v_add_f32 v73, v73, v66
    v_add_f32 v73, v73, v67
    v_add_f32 v73, v73, v68
    v_add_f32 v73, v73, v69
    v_add_f32 v73, v73, v70
    v_add_f32 v73, v73, v71
    s_waitcnt vmcnt(7)
    s_waitcnt vmcnt(6)
    s_cmp_eq_u32 s58, 2
    s_cbranch_scc1 L_i108
    s_waitcnt vmcnt(4)
    s_cbranch_vccz L_i108
    s_waitcnt vmcnt(4)
L_i108:
    buffer_load_dwordx4 v[148:151], v1, s[32:35], s53 offen offset:0 nt
    s_waitcnt lgkmcnt(0)
    v_readfirstlane_b32 s58, v75
    v_cmp_eq_u32 vcc, 0, v75
    v_add_f32_dpp v73, v73, v73 row_ror:8 row_mask:0xf bank_mask:0xf
    v_mov_b32 v74, v73
    s_nop 1
    v_permlane16_swap_b32 v73, v74
    v_add_f32 v73, v73, v74
    v_mov_b32 v74, v73
    s_nop 1
    v_permlane32_swap_b32 v73, v74
    v_add_f32 v73, v73, v74
    v_min_u32 v72, -2, v72
    v_min_u32 v73, -2, v73
    s_lshl_b32 s54, s3, 3
    v_mov_b32 v74, s54
    ds_write_b64 v74, v[72:73] offset:8736
    v_cvt_pk_bf16_f32 v40, v40, v40
    v_and_b32 v32, v4, v40
    v_and_b32 v33, v5, v40
    v_and_b32 v34, v6, v40
    v_and_b32 v35, v7, v40
    s_nop 1
    v_mfma_f32_16x16x32_bf16 v[20:23], v[32:35], v[100:103], 0
    v_cvt_pk_bf16_f32 v41, v41, v41
    v_and_b32 v36, v4, v41
    v_and_b32 v37, v5, v41
    v_and_b32 v38, v6, v41
    v_and_b32 v39, v7, v41
    v_mfma_f32_16x16x32_bf16 v[24:27], v[32:35], v[104:107], 0
    v_mfma_f32_16x16x32_bf16 v[28:31], v[32:35], v[108:111], 0
    v_mfma_f32_16x16x32_bf16 v[20:23], v[36:39], v[112:115], v[20:23]
    v_cvt_pk_bf16_f32 v42, v42, v42
    v_and_b32 v32, v4, v42
    v_and_b32 v33, v5, v42
    v_and_b32 v34, v6, v42
    v_and_b32 v35, v7, v42
    v_mfma_f32_16x16x32_bf16 v[24:27], v[36:39], v[116:119], v[24:27]
    s_waitcnt vmcnt(7)
    s_waitcnt vmcnt(6)
    s_cmp_eq_u32 s58, 2
    s_cbranch_scc1 L_i109
    s_waitcnt vmcnt(5)
    s_cbranch_vccz L_i109
    s_waitcnt vmcnt(4)
L_i109:
    buffer_load_dwordx4 v[152:155], v1, s[32:35], s53 offen offset:128 nt
    v_mfma_f32_16x16x32_bf16 v[28:31], v[36:39], v[120:123], v[28:31]
    s_waitcnt vmcnt(7)
    s_waitcnt vmcnt(6)
    s_cmp_eq_u32 s58, 2
    s_cbranch_scc1 L_i110
    s_waitcnt vmcnt(4)
    s_cbranch_vccz L_i110
    s_waitcnt vmcnt(4)
L_i110:
    buffer_load_dwordx4 v[156:159], v1, s[32:35], s53 offen offset:256 nt
    s_add_u32 s53, s59, 160
    s_and_b32 s53, s53, 1023
    s_mul_i32 s53, s53, 3072
    s_add_u32 s53, s53, s60
    v_mov_b32 v2, 102
    ds_read_b32 v75, v0 offset:8720
    ds_write_b32 v0, v2 offset:8704
    v_mfma_f32_16x16x32_bf16 v[20:23], v[32:35], v[124:127], v[20:23]
    v_cvt_pk_bf16_f32 v43, v43, v43
    v_and_b32 v36, v4, v43
    v_and_b32 v37, v5, v43
    v_and_b32 v38, v6, v43
    v_and_b32 v39, v7, v43
    s_waitcnt vmcnt(7)
    s_waitcnt vmcnt(6)
    s_cmp_eq_u32 s58, 2
    s_cbranch_scc1 L_i111
    s_waitcnt vmcnt(5)
    s_cbranch_vccz L_i111
    s_waitcnt vmcnt(4)
L_i111:
    buffer_load_dwordx4 v[160:163], v1, s[32:35], s53 offen offset:0 nt
    s_waitcnt lgkmcnt(0)
    v_readfirstlane_b32 s58, v75
    v_cmp_eq_u32 vcc, 0, v75
    v_mfma_f32_16x16x32_bf16 v[24:27], v[32:35], v[128:131], v[24:27]
    s_waitcnt vmcnt(7)
    s_waitcnt vmcnt(6)
    s_cmp_eq_u32 s58, 2
    s_cbranch_scc1 L_i112
    s_waitcnt vmcnt(4)
    s_cbranch_vccz L_i112
    s_waitcnt vmcnt(4)
L_i112:
    buffer_load_dwordx4 v[164:167], v1, s[32:35], s53 offen offset:128 nt
    v_mfma_f32_16x16x32_bf16 v[28:31], v[32:35], v[132:135], v[28:31]
    s_waitcnt vmcnt(7)
    s_waitcnt vmcnt(6)
    s_cmp_eq_u32 s58, 2
    s_cbranch_scc1 L_i113
    s_waitcnt vmcnt(5)
    s_cbranch_vccz L_i113
    s_waitcnt vmcnt(4)
L_i113:
    buffer_load_dwordx4 v[168:171], v1, s[32:35], s53 offen offset:256 nt
    s_add_u32 s53, s59, 192
    s_and_b32 s53, s53, 1023
    s_mul_i32 s53, s53, 3072
    s_add_u32 s53, s53, s60
    v_mov_b32 v2, 105
    ds_read_b32 v75, v0 offset:8720
    ds_write_b32 v0, v2 offset:8704
    v_mfma_f32_16x16x32_bf16 v[20:23], v[36:39], v[136:139], v[20:23]
    v_cvt_pk_bf16_f32 v44, v44, v44
    v_and_b32 v32, v4, v44
    v_and_b32 v33, v5, v44
    v_and_b32 v34, v6, v44
    v_and_b32 v35, v7, v44
    s_waitcnt vmcnt(7)
    s_waitcnt vmcnt(6)
    s_cmp_eq_u32 s58, 2
    s_cbranch_scc1 L_i114
    s_waitcnt vmcnt(4)
    s_cbranch_vccz L_i114
    s_waitcnt vmcnt(4)
L_i114:
    buffer_load_dwordx4 v[172:175], v1, s[32:35], s53 offen offset:0 nt
    s_waitcnt lgkmcnt(0)
    v_readfirstlane_b32 s58, v75
    v_cmp_eq_u32 vcc, 0, v75
    v_mfma_f32_16x16x32_bf16 v[24:27], v[36:39], v[140:143], v[24:27]
    s_waitcnt vmcnt(7)
    s_waitcnt vmcnt(6)
    s_cmp_eq_u32 s58, 2
    s_cbranch_scc1 L_i115
    s_waitcnt vmcnt(5)
    s_cbranch_vccz L_i115
    s_waitcnt vmcnt(4)
L_i115:
    buffer_load_dwordx4 v[176:179], v1, s[32:35], s53 offen offset:128 nt
    v_mfma_f32_16x16x32_bf16 v[28:31], v[36:39], v[144:147], v[28:31]
    s_waitcnt vmcnt(7)
    s_waitcnt vmcnt(6)
    s_cmp_eq_u32 s58, 2
    s_cbranch_scc1 L_i116
    s_waitcnt vmcnt(4)
    s_cbranch_vccz L_i116
    s_waitcnt vmcnt(4)
L_i116:
    buffer_load_dwordx4 v[180:183], v1, s[32:35], s53 offen offset:256 nt
    s_add_u32 s53, s59, 224
    s_and_b32 s53, s53, 1023
    s_mul_i32 s53, s53, 3072
    s_add_u32 s53, s53, s60
    v_mov_b32 v2, 108
    ds_read_b32 v75, v0 offset:8720
    ds_write_b32 v0, v2 offset:8704
    v_mfma_f32_16x16x32_bf16 v[20:23], v[32:35], v[148:151], v[20:23]
    v_cvt_pk_bf16_f32 v45, v45, v45
    v_and_b32 v36, v4, v45
    v_and_b32 v37, v5, v45
    v_and_b32 v38, v6, v45
    v_and_b32 v39, v7, v45
    s_waitcnt vmcnt(7)
    s_waitcnt vmcnt(6)
    s_cmp_eq_u32 s58, 2
    s_cbranch_scc1 L_i117
    s_waitcnt vmcnt(5)
    s_cbranch_vccz L_i117
    s_waitcnt vmcnt(4)
L_i117:
    buffer_load_dwordx4 v[184:187], v1, s[32:35], s53 offen offset:0 nt
    s_waitcnt lgkmcnt(0)
    v_readfirstlane_b32 s58, v75
    v_cmp_eq_u32 vcc, 0, v75
    v_mfma_f32_16x16x32_bf16 v[24:27], v[32:35], v[152:155], v[24:27]
    s_waitcnt vmcnt(7)
    s_waitcnt vmcnt(6)
    s_cmp_eq_u32 s58, 2
    s_cbranch_scc1 L_i118
    s_waitcnt vmcnt(4)
    s_cbranch_vccz L_i118
    s_waitcnt vmcnt(4)
L_i118:
    buffer_load_dwordx4 v[188:191], v1, s[32:35], s53 offen offset:128 nt
    v_mfma_f32_16x16x32_bf16 v[28:31], v[32:35], v[156:159], v[28:31]
    s_waitcnt vmcnt(7)
    s_waitcnt vmcnt(6)
    s_cmp_eq_u32 s58, 2
    s_cbranch_scc1 L_i119
    s_waitcnt vmcnt(5)
    s_cbranch_vccz L_i119
    s_waitcnt vmcnt(4)
L_i119:
    buffer_load_dwordx4 v[192:195], v1, s[32:35], s53 offen offset:256 nt
    s_add_u32 s53, s59, 256
    s_and_b32 s53, s53, 1023
    s_mul_i32 s53, s53, 3072
    s_add_u32 s53, s53, s60
    v_mov_b32 v2, 111
    ds_read_b32 v75, v0 offset:8720
    ds_write_b32 v0, v2 offset:8704
    v_mfma_f32_16x16x32_bf16 v[20:23], v[36:39], v[160:163], v[20:23]
    v_cvt_pk_bf16_f32 v46, v46, v46
    v_and_b32 v32, v4, v46
    v_and_b32 v33, v5, v46
    v_and_b32 v34, v6, v46
    v_and_b32 v35, v7, v46
    s_waitcnt vmcnt(7)
    s_waitcnt vmcnt(6)
    s_cmp_eq_u32 s58, 2
    s_cbranch_scc1 L_i120
    s_waitcnt vmcnt(4)
    s_cbranch_vccz L_i120
    s_waitcnt vmcnt(4)
L_i120:
    buffer_load_dwordx4 v[196:199], v1, s[32:35], s53 offen offset:0 nt
    s_waitcnt lgkmcnt(0)
    v_readfirstlane_b32 s58, v75
    v_cmp_eq_u32 vcc, 0, v75
    v_mfma_f32_16x16x32_bf16 v[24:27], v[36:39], v[164:167], v[24:27]
    s_waitcnt vmcnt(7)
    s_waitcnt vmcnt(6)
    s_cmp_eq_u32 s58, 2
    s_cbranch_scc1 L_i121
    s_waitcnt vmcnt(5)
    s_cbranch_vccz L_i121
    s_waitcnt vmcnt(4)
L_i121:
    buffer_load_dwordx4 v[200:203], v1, s[32:35], s53 offen offset:128 nt
    v_mfma_f32_16x16x32_bf16 v[28:31], v[36:39], v[168:171], v[28:31]
    s_waitcnt vmcnt(7)
    s_waitcnt vmcnt(6)
    s_cmp_eq_u32 s58, 2
    s_cbranch_scc1 L_i122
    s_waitcnt vmcnt(4)
    s_cbranch_vccz L_i122
    s_waitcnt vmcnt(4)
L_i122:
    buffer_load_dwordx4 v[204:207], v1, s[32:35], s53 offen offset:256 nt
    s_add_u32 s53, s59, 288
    s_and_b32 s53, s53, 1023
    s_mul_i32 s53, s53, 3072
    s_add_u32 s53, s53, s60
    v_mov_b32 v2, 114
    ds_read_b32 v75, v0 offset:8720
    ds_write_b32 v0, v2 offset:8704
    v_mfma_f32_16x16x32_bf16 v[20:23], v[32:35], v[172:175], v[20:23]
    v_cvt_pk_bf16_f32 v47, v47, v47
    v_and_b32 v36, v4, v47
    v_and_b32 v37, v5, v47
    v_and_b32 v38, v6, v47
    v_and_b32 v39, v7, v47
    s_waitcnt vmcnt(7)
    s_waitcnt vmcnt(6)
    s_cmp_eq_u32 s58, 2
    s_cbranch_scc1 L_i123
    s_waitcnt vmcnt(5)
    s_cbranch_vccz L_i123
    s_waitcnt vmcnt(4)
L_i123:
    buffer_load_dwordx4 v[208:211], v1, s[32:35], s53 offen offset:0 nt
    s_waitcnt lgkmcnt(0)
    v_readfirstlane_b32 s58, v75
    v_cmp_eq_u32 vcc, 0, v75
    v_mfma_f32_16x16x32_bf16 v[24:27], v[32:35], v[176:179], v[24:27]
    s_waitcnt vmcnt(7)
    s_waitcnt vmcnt(6)
    s_cmp_eq_u32 s58, 2
    s_cbranch_scc1 L_i124
    s_waitcnt vmcnt(4)
    s_cbranch_vccz L_i124
    s_waitcnt vmcnt(4)
L_i124:
    buffer_load_dwordx4 v[212:215], v1, s[32:35], s53 offen offset:128 nt
    v_mfma_f32_16x16x32_bf16 v[28:31], v[32:35], v[180:183], v[28:31]
    s_waitcnt vmcnt(7)
    s_waitcnt vmcnt(6)
    s_cmp_eq_u32 s58, 2
    s_cbranch_scc1 L_i125
    s_waitcnt vmcnt(5)
    s_cbranch_vccz L_i125
    s_waitcnt vmcnt(4)
L_i125:
    buffer_load_dwordx4 v[216:219], v1, s[32:35], s53 offen offset:256 nt
    s_add_u32 s53, s59, 320
    s_and_b32 s53, s53, 1023
    s_mul_i32 s53, s53, 3072
    s_add_u32 s53, s53, s60
    v_mov_b32 v2, 117
    ds_read_b32 v75, v0 offset:8720
    ds_write_b32 v0, v2 offset:8704
    v_mfma_f32_16x16x32_bf16 v[20:23], v[36:39], v[184:187], v[20:23]
    v_cvt_pk_bf16_f32 v48, v48, v48
    v_and_b32 v32, v4, v48
    v_and_b32 v33, v5, v48
    v_and_b32 v34, v6, v48
    v_and_b32 v35, v7, v48
    s_waitcnt vmcnt(7)
    s_waitcnt vmcnt(6)
    s_cmp_eq_u32 s58, 2
    s_cbranch_scc1 L_i126
    s_waitcnt vmcnt(4)
    s_cbranch_vccz L_i126
    s_waitcnt vmcnt(4)
L_i126:
    buffer_load_dwordx4 v[220:223], v1, s[32:35], s53 offen offset:0 nt
    s_waitcnt lgkmcnt(0)
    v_readfirstlane_b32 s58, v75
    v_cmp_eq_u32 vcc, 0, v75
    v_mfma_f32_16x16x32_bf16 v[24:27], v[36:39], v[188:191], v[24:27]
    s_waitcnt vmcnt(7)
    s_waitcnt vmcnt(6)
    s_cmp_eq_u32 s58, 2
    s_cbranch_scc1 L_i127
    s_waitcnt vmcnt(5)
    s_cbranch_vccz L_i127
    s_waitcnt vmcnt(4)
L_i127:
    buffer_load_dwordx4 v[224:227], v1, s[32:35], s53 offen offset:128 nt
    v_mfma_f32_16x16x32_bf16 v[28:31], v[36:39], v[192:195], v[28:31]
    s_waitcnt vmcnt(7)
    s_waitcnt vmcnt(6)
    s_cmp_eq_u32 s58, 2
    s_cbranch_scc1 L_i128
    s_waitcnt vmcnt(4)
    s_cbranch_vccz L_i128
    s_waitcnt vmcnt(4)
L_i128:
    buffer_load_dwordx4 v[228:231], v1, s[32:35], s53 offen offset:256 nt
    s_add_u32 s53, s59, 352
    s_and_b32 s53, s53, 1023
    s_mul_i32 s53, s53, 3072
    s_add_u32 s53, s53, s60
    s_barrier
    v_mov_b32 v2, 120
    ds_read_b32 v75, v0 offset:8720
    ds_write_b32 v0, v2 offset:8704
    v_mfma_f32_16x16x32_bf16 v[20:23], v[32:35], v[196:199], v[20:23]
    v_cvt_pk_bf16_f32 v49, v49, v49
    v_and_b32 v36, v4, v49
    v_and_b32 v37, v5, v49
    v_and_b32 v38, v6, v49
    v_and_b32 v39, v7, v49
    s_waitcnt vmcnt(7)
    s_waitcnt vmcnt(6)
    s_cmp_eq_u32 s58, 2
    s_cbranch_scc1 L_i129
    s_waitcnt vmcnt(5)
    s_cbranch_vccz L_i129
    s_waitcnt vmcnt(4)
L_i129:
    buffer_load_dwordx4 v[232:235], v1, s[32:35], s53 offen offset:0 nt
    s_waitcnt lgkmcnt(0)
    v_readfirstlane_b32 s58, v75
    v_cmp_eq_u32 vcc, 0, v75
    v_mfma_f32_16x16x32_bf16 v[24:27], v[32:35], v[200:203], v[24:27]
    s_waitcnt vmcnt(7)
    s_waitcnt vmcnt(6)
    s_cmp_eq_u32 s58, 2
    s_cbranch_scc1 L_i130
    s_waitcnt vmcnt(4)
    s_cbranch_vccz L_i130
    s_waitcnt vmcnt(4)
L_i130:
    buffer_load_dwordx4 v[236:239], v1, s[32:35], s53 offen offset:128 nt
    v_mfma_f32_16x16x32_bf16 v[28:31], v[32:35], v[204:207], v[28:31]
    s_waitcnt vmcnt(7)
    s_waitcnt vmcnt(6)
    s_cmp_eq_u32 s58, 2
    s_cbranch_scc1 L_i131
    s_waitcnt vmcnt(5)
    s_cbranch_vccz L_i131
    s_waitcnt vmcnt(4)
L_i131:
    buffer_load_dwordx4 v[240:243], v1, s[32:35], s53 offen offset:256 nt
    s_add_u32 s53, s59, 384
    s_and_b32 s53, s53, 1023
    s_mul_i32 s53, s53, 3072
    s_add_u32 s53, s53, s60
    v_mov_b32 v2, 123
    ds_read_b32 v75, v0 offset:8720
    ds_write_b32 v0, v2 offset:8704
    v_mfma_f32_16x16x32_bf16 v[20:23], v[36:39], v[208:211], v[20:23]
    v_cvt_pk_bf16_f32 v50, v50, v50
    v_and_b32 v32, v4, v50
    v_and_b32 v33, v5, v50
    v_and_b32 v34, v6, v50
    v_and_b32 v35, v7, v50
    s_waitcnt vmcnt(7)
    s_waitcnt vmcnt(6)
    s_cmp_eq_u32 s58, 2
    s_cbranch_scc1 L_i132
    s_waitcnt vmcnt(4)
    s_cbranch_vccz L_i132
    s_waitcnt vmcnt(4)
L_i132:
    buffer_load_dwordx4 v[244:247], v1, s[32:35], s53 offen offset:0 nt
    s_waitcnt lgkmcnt(0)
    v_readfirstlane_b32 s58, v75
    v_cmp_eq_u32 vcc, 0, v75
    v_mfma_f32_16x16x32_bf16 v[24:27], v[36:39], v[212:215], v[24:27]
    s_waitcnt vmcnt(7)
    s_waitcnt vmcnt(6)
    s_cmp_eq_u32 s58, 2
    s_cbranch_scc1 L_i133
    s_waitcnt vmcnt(5)
    s_cbranch_vccz L_i133
    s_waitcnt vmcnt(4)
L_i133:
    buffer_load_dwordx4 v[248:251], v1, s[32:35], s53 offen offset:128 nt
    v_mfma_f32_16x16x32_bf16 v[28:31], v[36:39], v[216:219], v[28:31]
    s_waitcnt vmcnt(7)
    s_waitcnt vmcnt(6)
    s_cmp_eq_u32 s58, 2
    s_cbranch_scc1 L_i134
    s_waitcnt vmcnt(4)
    s_cbranch_vccz L_i134
    s_waitcnt vmcnt(4)
L_i134:
    buffer_load_dwordx4 v[252:255], v1, s[32:35], s53 offen offset:256 nt
    s_add_u32 s53, s59, 416
    s_and_b32 s53, s53, 1023
    s_mul_i32 s53, s53, 3072
    s_add_u32 s53, s53, s60
    v_mov_b32 v2, 126
    ds_read_b32 v75, v0 offset:8720
    ds_write_b32 v0, v2 offset:8704
    v_mfma_f32_16x16x32_bf16 v[20:23], v[32:35], v[220:223], v[20:23]
    v_cvt_pk_bf16_f32 v51, v51, v51
    v_and_b32 v36, v4, v51
    v_and_b32 v37, v5, v51
    v_and_b32 v38, v6, v51
    v_and_b32 v39, v7, v51
    s_waitcnt vmcnt(7)
    s_waitcnt vmcnt(6)
    s_cmp_eq_u32 s58, 2
    s_cbranch_scc1 L_i135
    s_waitcnt vmcnt(5)
    s_cbranch_vccz L_i135
    s_waitcnt vmcnt(4)
L_i135:
    buffer_load_dwordx4 v[76:79], v1, s[32:35], s53 offen offset:0 nt
    s_waitcnt lgkmcnt(0)
    v_readfirstlane_b32 s58, v75
    v_cmp_eq_u32 vcc, 0, v75
    v_mfma_f32_16x16x32_bf16 v[24:27], v[32:35], v[224:227], v[24:27]
    s_waitcnt vmcnt(7)
    s_waitcnt vmcnt(6)
    s_cmp_eq_u32 s58, 2
    s_cbranch_scc1 L_i136
    s_waitcnt vmcnt(4)
    s_cbranch_vccz L_i136
    s_waitcnt vmcnt(4)
L_i136:
    buffer_load_dwordx4 v[80:83], v1, s[32:35], s53 offen offset:128 nt
    v_mfma_f32_16x16x32_bf16 v[28:31], v[32:35], v[228:231], v[28:31]
    s_waitcnt vmcnt(7)
    s_waitcnt vmcnt(6)
    s_cmp_eq_u32 s58, 2
    s_cbranch_scc1 L_i137
    s_waitcnt vmcnt(5)
    s_cbranch_vccz L_i137
    s_waitcnt vmcnt(4)
L_i137:
    buffer_load_dwordx4 v[84:87], v1, s[32:35], s53 offen offset:256 nt
    s_add_u32 s53, s59, 448
    s_and_b32 s53, s53, 1023
    s_mul_i32 s53, s53, 3072
    s_add_u32 s53, s53, s60
    v_mov_b32 v2, 129
    ds_read_b32 v75, v0 offset:8720
    ds_write_b32 v0, v2 offset:8704
    v_mfma_f32_16x16x32_bf16 v[20:23], v[36:39], v[232:235], v[20:23]
    v_cvt_pk_bf16_f32 v52, v52, v52
    v_and_b32 v32, v4, v52
    v_and_b32 v33, v5, v52
    v_and_b32 v34, v6, v52
    v_and_b32 v35, v7, v52
    s_waitcnt vmcnt(7)
    s_waitcnt vmcnt(6)
    s_cmp_eq_u32 s58, 2
    s_cbranch_scc1 L_i138
    s_waitcnt vmcnt(4)
    s_cbranch_vccz L_i138
    s_waitcnt vmcnt(4)
L_i138:
    buffer_load_dwordx4 v[88:91], v1, s[32:35], s53 offen offset:0 nt
    s_waitcnt lgkmcnt(0)
    v_readfirstlane_b32 s58, v75
    v_cmp_eq_u32 vcc, 0, v75
    v_mfma_f32_16x16x32_bf16 v[24:27], v[36:39], v[236:239], v[24:27]
    s_waitcnt vmcnt(7)
    s_waitcnt vmcnt(6)
    s_cmp_eq_u32 s58, 2
    s_cbranch_scc1 L_i139
    s_waitcnt vmcnt(5)
    s_cbranch_vccz L_i139
    s_waitcnt vmcnt(4)
L_i139:
    buffer_load_dwordx4 v[92:95], v1, s[32:35], s53 offen offset:128 nt
    v_mfma_f32_16x16x32_bf16 v[28:31], v[36:39], v[240:243], v[28:31]
    s_waitcnt vmcnt(7)
    s_waitcnt vmcnt(6)
    s_cmp_eq_u32 s58, 2
    s_cbranch_scc1 L_i140
    s_waitcnt vmcnt(4)
    s_cbranch_vccz L_i140
    s_waitcnt vmcnt(4)
L_i140:
    buffer_load_dwordx4 v[96:99], v1, s[32:35], s53 offen offset:256 nt
    s_add_u32 s53, s59, 480
    s_and_b32 s53, s53, 1023
    s_mul_i32 s53, s53, 3072
    s_add_u32 s53, s53, s60
    v_mov_b32 v2, 132
    ds_read_b32 v75, v0 offset:8720
    ds_write_b32 v0, v2 offset:8704
    v_mfma_f32_16x16x32_bf16 v[20:23], v[32:35], v[244:247], v[20:23]
    v_cvt_pk_bf16_f32 v53, v53, v53
    v_and_b32 v36, v4, v53
    v_and_b32 v37, v5, v53
    v_and_b32 v38, v6, v53
    v_and_b32 v39, v7, v53
    s_waitcnt vmcnt(7)
    s_waitcnt vmcnt(6)
    s_cmp_eq_u32 s58, 2
    s_cbranch_scc1 L_i141
    s_waitcnt vmcnt(5)
    s_cbranch_vccz L_i141
    s_waitcnt vmcnt(4)
L_i141:
    buffer_load_dwordx4 v[100:103], v1, s[32:35], s53 offen offset:0 nt
    s_waitcnt lgkmcnt(0)
    v_readfirstlane_b32 s58, v75
    v_cmp_eq_u32 vcc, 0, v75
    v_mfma_f32_16x16x32_bf16 v[24:27], v[32:35], v[248:251], v[24:27]
    s_waitcnt vmcnt(7)
    s_waitcnt vmcnt(6)
    s_cmp_eq_u32 s58, 2
    s_cbranch_scc1 L_i142
    s_waitcnt vmcnt(4)
    s_cbranch_vccz L_i142
    s_waitcnt vmcnt(4)
L_i142:
    buffer_load_dwordx4 v[104:107], v1, s[32:35], s53 offen offset:128 nt
    v_mfma_f32_16x16x32_bf16 v[28:31], v[32:35], v[252:255], v[28:31]
    s_waitcnt vmcnt(7)
    s_waitcnt vmcnt(6)
    s_cmp_eq_u32 s58, 2
    s_cbranch_scc1 L_i143
    s_waitcnt vmcnt(5)
    s_cbranch_vccz L_i143
    s_waitcnt vmcnt(4)
L_i143:
    buffer_load_dwordx4 v[108:111], v1, s[32:35], s53 offen offset:256 nt
    s_add_u32 s53, s59, 512
    s_and_b32 s53, s53, 1023
    s_mul_i32 s53, s53, 3072
    s_add_u32 s53, s53, s60
    v_mov_b32 v2, 135
    ds_read_b32 v75, v0 offset:8720
    ds_write_b32 v0, v2 offset:8704
    v_mfma_f32_16x16x32_bf16 v[20:23], v[36:39], v[76:79], v[20:23]
    v_cvt_pk_bf16_f32 v54, v54, v54
    v_and_b32 v32, v4, v54
    v_and_b32 v33, v5, v54
    v_and_b32 v34, v6, v54
    v_and_b32 v35, v7, v54
    s_waitcnt vmcnt(7)
    s_waitcnt vmcnt(6)
    s_cmp_eq_u32 s58, 2
    s_cbranch_scc1 L_i144
    s_waitcnt vmcnt(4)
    s_cbranch_vccz L_i144
    s_waitcnt vmcnt(4)
L_i144:
    buffer_load_dwordx4 v[112:115], v1, s[32:35], s53 offen offset:0 nt
    s_waitcnt lgkmcnt(0)
    v_readfirstlane_b32 s58, v75
    v_cmp_eq_u32 vcc, 0, v75
    v_mfma_f32_16x16x32_bf16 v[24:27], v[36:39], v[80:83], v[24:27]
    s_waitcnt vmcnt(7)
    s_waitcnt vmcnt(6)
    s_cmp_eq_u32 s58, 2
    s_cbranch_scc1 L_i145
    s_waitcnt vmcnt(5)
    s_cbranch_vccz L_i145
    s_waitcnt vmcnt(4)
L_i145:
    buffer_load_dwordx4 v[116:119], v1, s[32:35], s53 offen offset:128 nt
    v_mfma_f32_16x16x32_bf16 v[28:31], v[36:39], v[84:87], v[28:31]
    s_waitcnt vmcnt(7)
    s_waitcnt vmcnt(6)
    s_cmp_eq_u32 s58, 2
    s_cbranch_scc1 L_i146
    s_waitcnt vmcnt(4)
    s_cbranch_vccz L_i146
    s_waitcnt vmcnt(4)
L_i146:
    buffer_load_dwordx4 v[120:123], v1, s[32:35], s53 offen offset:256 nt
    s_add_u32 s53, s59, 544
    s_and_b32 s53, s53, 1023
    s_mul_i32 s53, s53, 3072
    s_add_u32 s53, s53, s60
    v_mov_b32 v2, 138
    ds_read_b32 v75, v0 offset:8720
    ds_write_b32 v0, v2 offset:8704
    v_mfma_f32_16x16x32_bf16 v[20:23], v[32:35], v[88:91], v[20:23]
    v_cvt_pk_bf16_f32 v55, v55, v55
    v_and_b32 v36, v4, v55
    v_and_b32 v37, v5, v55
    v_and_b32 v38, v6, v55
    v_and_b32 v39, v7, v55
    s_waitcnt vmcnt(7)
    s_waitcnt vmcnt(6)
    s_cmp_eq_u32 s58, 2
    s_cbranch_scc1 L_i147
    s_waitcnt vmcnt(5)
    s_cbranch_vccz L_i147
    s_waitcnt vmcnt(4)
L_i147:
    buffer_load_dwordx4 v[124:127], v1, s[32:35], s53 offen offset:0 nt
    s_waitcnt lgkmcnt(0)
    v_readfirstlane_b32 s58, v75
    v_cmp_eq_u32 vcc, 0, v75
    v_mfma_f32_16x16x32_bf16 v[24:27], v[32:35], v[92:95], v[24:27]
    s_waitcnt vmcnt(7)
    s_waitcnt vmcnt(6)
    s_cmp_eq_u32 s58, 2
    s_cbranch_scc1 L_i148
    s_waitcnt vmcnt(4)
    s_cbranch_vccz L_i148
    s_waitcnt vmcnt(4)
L_i148:
    buffer_load_dwordx4 v[128:131], v1, s[32:35], s53 offen offset:128 nt
    v_mfma_f32_16x16x32_bf16 v[28:31], v[32:35], v[96:99], v[28:31]
    s_waitcnt vmcnt(7)
    s_waitcnt vmcnt(6)
    s_cmp_eq_u32 s58, 2
    s_cbranch_scc1 L_i149
    s_waitcnt vmcnt(5)
    s_cbranch_vccz L_i149
    s_waitcnt vmcnt(4)
L_i149:
    buffer_load_dwordx4 v[132:135], v1, s[32:35], s53 offen offset:256 nt
    s_add_u32 s53, s59, 576
    s_and_b32 s53, s53, 1023
    s_mul_i32 s53, s53, 3072
    s_add_u32 s53, s53, s60
    v_mov_b32 v2, 141
    ds_read_b32 v75, v0 offset:8720
    ds_write_b32 v0, v2 offset:8704
    v_mfma_f32_16x16x32_bf16 v[20:23], v[36:39], v[100:103], v[20:23]
    v_cvt_pk_bf16_f32 v56, v56, v56
    v_and_b32 v32, v4, v56
    v_and_b32 v33, v5, v56
    v_and_b32 v34, v6, v56
    v_and_b32 v35, v7, v56
    s_waitcnt vmcnt(7)
    s_waitcnt vmcnt(6)
    s_cmp_eq_u32 s58, 2
    s_cbranch_scc1 L_i150
    s_waitcnt vmcnt(4)
    s_cbranch_vccz L_i150
    s_waitcnt vmcnt(4)
L_i150:
    buffer_load_dwordx4 v[136:139], v1, s[32:35], s53 offen offset:0 nt
    s_waitcnt lgkmcnt(0)
    v_readfirstlane_b32 s58, v75
    v_cmp_eq_u32 vcc, 0, v75
    v_mfma_f32_16x16x32_bf16 v[24:27], v[36:39], v[104:107], v[24:27]
    s_waitcnt vmcnt(7)
    s_waitcnt vmcnt(6)
    s_cmp_eq_u32 s58, 2
    s_cbranch_scc1 L_i151
    s_waitcnt vmcnt(5)
    s_cbranch_vccz L_i151
    s_waitcnt vmcnt(4)
L_i151:
    buffer_load_dwordx4 v[140:143], v1, s[32:35], s53 offen offset:128 nt
    v_mfma_f32_16x16x32_bf16 v[28:31], v[36:39], v[108:111], v[28:31]
    s_waitcnt vmcnt(7)
    s_waitcnt vmcnt(6)
    s_cmp_eq_u32 s58, 2
    s_cbranch_scc1 L_i152
    s_waitcnt vmcnt(4)
    s_cbranch_vccz L_i152
    s_waitcnt vmcnt(4)
L_i152:
    buffer_load_dwordx4 v[144:147], v1, s[32:35], s53 offen offset:256 nt
    s_add_u32 s53, s59, 608
    s_and_b32 s53, s53, 1023
    s_mul_i32 s53, s53, 3072
    s_add_u32 s53, s53, s60
    v_mov_b32 v2, 144
    ds_read_b32 v75, v0 offset:8720
    ds_write_b32 v0, v2 offset:8704
    v_mfma_f32_16x16x32_bf16 v[20:23], v[32:35], v[112:115], v[20:23]
    v_cvt_pk_bf16_f32 v57, v57, v57
    v_and_b32 v36, v4, v57
    v_and_b32 v37, v5, v57
    v_and_b32 v38, v6, v57
    v_and_b32 v39, v7, v57
    s_waitcnt vmcnt(7)
    s_waitcnt vmcnt(6)
    s_cmp_eq_u32 s58, 2
    s_cbranch_scc1 L_i153
    s_waitcnt vmcnt(5)
    s_cbranch_vccz L_i153
    s_waitcnt vmcnt(4)
L_i153:
    buffer_load_dwordx4 v[148:151], v1, s[32:35], s53 offen offset:0 nt
    s_waitcnt lgkmcnt(0)
    v_readfirstlane_b32 s58, v75
    v_cmp_eq_u32 vcc, 0, v75
    v_mfma_f32_16x16x32_bf16 v[24:27], v[32:35], v[116:119], v[24:27]
    s_waitcnt vmcnt(7)
    s_waitcnt vmcnt(6)
    s_cmp_eq_u32 s58, 2
    s_cbranch_scc1 L_i154
    s_waitcnt vmcnt(4)
    s_cbranch_vccz L_i154
    s_waitcnt vmcnt(4)
L_i154:
    buffer_load_dwordx4 v[152:155], v1, s[32:35], s53 offen offset:128 nt
    v_mfma_f32_16x16x32_bf16 v[28:31], v[32:35], v[120:123], v[28:31]
    s_waitcnt vmcnt(7)
    s_waitcnt vmcnt(6)
    s_cmp_eq_u32 s58, 2
    s_cbranch_scc1 L_i155
    s_waitcnt vmcnt(5)
    s_cbranch_vccz L_i155
    s_waitcnt vmcnt(4)
L_i155:
    buffer_load_dwordx4 v[156:159], v1, s[32:35], s53 offen offset:256 nt
    s_add_u32 s53, s59, 640
    s_and_b32 s53, s53, 1023
    s_mul_i32 s53, s53, 3072
    s_add_u32 s53, s53, s60
    v_mov_b32 v2, 147
    ds_read_b32 v75, v0 offset:8720
    ds_write_b32 v0, v2 offset:8704
    v_mfma_f32_16x16x32_bf16 v[20:23], v[36:39], v[124:127], v[20:23]
    v_cvt_pk_bf16_f32 v58, v58, v58
    v_and_b32 v32, v4, v58
    v_and_b32 v33, v5, v58
    v_and_b32 v34, v6, v58
    v_and_b32 v35, v7, v58
    s_waitcnt vmcnt(7)
    s_waitcnt vmcnt(6)
    s_cmp_eq_u32 s58, 2
    s_cbranch_scc1 L_i156
    s_waitcnt vmcnt(4)
    s_cbranch_vccz L_i156
    s_waitcnt vmcnt(4)
L_i156:
    buffer_load_dwordx4 v[160:163], v1, s[32:35], s53 offen offset:0 nt
    s_waitcnt lgkmcnt(0)
    v_readfirstlane_b32 s58, v75
    v_cmp_eq_u32 vcc, 0, v75
    v_mfma_f32_16x16x32_bf16 v[24:27], v[36:39], v[128:131], v[24:27]
    s_waitcnt vmcnt(7)
    s_waitcnt vmcnt(6)
    s_cmp_eq_u32 s58, 2
    s_cbranch_scc1 L_i157
    s_waitcnt vmcnt(5)
    s_cbranch_vccz L_i157
    s_waitcnt vmcnt(4)
L_i157:
    buffer_load_dwordx4 v[164:167], v1, s[32:35], s53 offen offset:128 nt
    v_mfma_f32_16x16x32_bf16 v[28:31], v[36:39], v[132:135], v[28:31]
    s_waitcnt vmcnt(7)
    s_waitcnt vmcnt(6)
    s_cmp_eq_u32 s58, 2
    s_cbranch_scc1 L_i158
    s_waitcnt vmcnt(4)
    s_cbranch_vccz L_i158
    s_waitcnt vmcnt(4)
L_i158:
    buffer_load_dwordx4 v[168:171], v1, s[32:35], s53 offen offset:256 nt
    s_add_u32 s53, s59, 672
    s_and_b32 s53, s53, 1023
    s_mul_i32 s53, s53, 3072
    s_add_u32 s53, s53, s60
    v_mov_b32 v2, 150
    ds_read_b32 v75, v0 offset:8720
    ds_write_b32 v0, v2 offset:8704
    v_mfma_f32_16x16x32_bf16 v[20:23], v[32:35], v[136:139], v[20:23]
    v_cvt_pk_bf16_f32 v59, v59, v59
    v_and_b32 v36, v4, v59
    v_and_b32 v37, v5, v59
    v_and_b32 v38, v6, v59
    v_and_b32 v39, v7, v59
    s_waitcnt vmcnt(7)
    s_waitcnt vmcnt(6)
    s_cmp_eq_u32 s58, 2
    s_cbranch_scc1 L_i159
    s_waitcnt vmcnt(5)
    s_cbranch_vccz L_i159
    s_waitcnt vmcnt(4)
L_i159:
    buffer_load_dwordx4 v[172:175], v1, s[32:35], s53 offen offset:0 nt
    s_waitcnt lgkmcnt(0)
    v_readfirstlane_b32 s58, v75
    v_cmp_eq_u32 vcc, 0, v75
    v_mfma_f32_16x16x32_bf16 v[24:27], v[32:35], v[140:143], v[24:27]
    s_waitcnt vmcnt(7)
    s_waitcnt vmcnt(6)
    s_cmp_eq_u32 s58, 2
    s_cbranch_scc1 L_i160
    s_waitcnt vmcnt(4)
    s_cbranch_vccz L_i160
    s_waitcnt vmcnt(4)
L_i160:
    buffer_load_dwordx4 v[176:179], v1, s[32:35], s53 offen offset:128 nt
    v_mfma_f32_16x16x32_bf16 v[28:31], v[32:35], v[144:147], v[28:31]
    s_waitcnt vmcnt(7)
    s_waitcnt vmcnt(6)
    s_cmp_eq_u32 s58, 2
    s_cbranch_scc1 L_i161
    s_waitcnt vmcnt(5)
    s_cbranch_vccz L_i161
    s_waitcnt vmcnt(4)
L_i161:
    buffer_load_dwordx4 v[180:183], v1, s[32:35], s53 offen offset:256 nt
    s_add_u32 s53, s59, 704
    s_and_b32 s53, s53, 1023
    s_mul_i32 s53, s53, 3072
    s_add_u32 s53, s53, s60
    v_mov_b32 v2, 153
    ds_read_b32 v75, v0 offset:8720
    ds_write_b32 v0, v2 offset:8704
    v_mfma_f32_16x16x32_bf16 v[20:23], v[36:39], v[148:151], v[20:23]
    v_cvt_pk_bf16_f32 v60, v60, v60
    v_and_b32 v32, v4, v60
    v_and_b32 v33, v5, v60
    v_and_b32 v34, v6, v60
    v_and_b32 v35, v7, v60
    s_waitcnt vmcnt(7)
    s_waitcnt vmcnt(6)
    s_cmp_eq_u32 s58, 2
    s_cbranch_scc1 L_i162
    s_waitcnt vmcnt(4)
    s_cbranch_vccz L_i162
    s_waitcnt vmcnt(4)
L_i162:
    buffer_load_dwordx4 v[184:187], v1, s[32:35], s53 offen offset:0 nt
    s_waitcnt lgkmcnt(0)
    v_readfirstlane_b32 s58, v75
    v_cmp_eq_u32 vcc, 0, v75
    v_mfma_f32_16x16x32_bf16 v[24:27], v[36:39], v[152:155], v[24:27]
    s_waitcnt vmcnt(7)
    s_waitcnt vmcnt(6)
    s_cmp_eq_u32 s58, 2
    s_cbranch_scc1 L_i163
    s_waitcnt vmcnt(5)
    s_cbranch_vccz L_i163
    s_waitcnt vmcnt(4)
L_i163:
    buffer_load_dwordx4 v[188:191], v1, s[32:35], s53 offen offset:128 nt
    v_mfma_f32_16x16x32_bf16 v[28:31], v[36:39], v[156:159], v[28:31]
    s_waitcnt vmcnt(7)
    s_waitcnt vmcnt(6)
    s_cmp_eq_u32 s58, 2
    s_cbranch_scc1 L_i164
    s_waitcnt vmcnt(4)
    s_cbranch_vccz L_i164
    s_waitcnt vmcnt(4)
L_i164:
    buffer_load_dwordx4 v[192:195], v1, s[32:35], s53 offen offset:256 nt
    s_add_u32 s53, s59, 736
    s_and_b32 s53, s53, 1023
    s_mul_i32 s53, s53, 3072
    s_add_u32 s53, s53, s60
    v_mov_b32 v2, 156
    ds_read_b32 v75, v0 offset:8720
    ds_write_b32 v0, v2 offset:8704
    v_mfma_f32_16x16x32_bf16 v[20:23], v[32:35], v[160:163], v[20:23]
    v_cvt_pk_bf16_f32 v61, v61, v61
    v_and_b32 v36, v4, v61
    v_and_b32 v37, v5, v61
    v_and_b32 v38, v6, v61
    v_and_b32 v39, v7, v61
    s_waitcnt vmcnt(7)
    s_waitcnt vmcnt(6)
    s_cmp_eq_u32 s58, 2
    s_cbranch_scc1 L_i165
    s_waitcnt vmcnt(5)
    s_cbranch_vccz L_i165
    s_waitcnt vmcnt(4)
L_i165:
    buffer_load_dwordx4 v[196:199], v1, s[32:35], s53 offen offset:0 nt
    s_waitcnt lgkmcnt(0)
    v_readfirstlane_b32 s58, v75
    v_cmp_eq_u32 vcc, 0, v75
    v_mfma_f32_16x16x32_bf16 v[24:27], v[32:35], v[164:167], v[24:27]
    s_waitcnt vmcnt(7)
    s_waitcnt vmcnt(6)
    s_cmp_eq_u32 s58, 2
    s_cbranch_scc1 L_i166
    s_waitcnt vmcnt(4)
    s_cbranch_vccz L_i166
    s_waitcnt vmcnt(4)
L_i166:
    buffer_load_dwordx4 v[200:203], v1, s[32:35], s53 offen offset:128 nt
    v_mfma_f32_16x16x32_bf16 v[28:31], v[32:35], v[168:171], v[28:31]
    s_waitcnt vmcnt(7)
    s_waitcnt vmcnt(6)
    s_cmp_eq_u32 s58, 2
    s_cbranch_scc1 L_i167
    s_waitcnt vmcnt(5)
    s_cbranch_vccz L_i167
    s_waitcnt vmcnt(4)
L_i167:
    buffer_load_dwordx4 v[204:207], v1, s[32:35], s53 offen offset:256 nt
    s_add_u32 s53, s59, 768
    s_and_b32 s53, s53, 1023
    s_mul_i32 s53, s53, 3072
    s_add_u32 s53, s53, s60
    v_mov_b32 v2, 159
    ds_read_b32 v75, v0 offset:8720
    ds_write_b32 v0, v2 offset:8704
    v_mfma_f32_16x16x32_bf16 v[20:23], v[36:39], v[172:175], v[20:23]
    v_cvt_pk_bf16_f32 v62, v62, v62
    v_and_b32 v32, v4, v62
    v_and_b32 v33, v5, v62
    v_and_b32 v34, v6, v62
    v_and_b32 v35, v7, v62
    s_waitcnt vmcnt(7)
    s_waitcnt vmcnt(6)
    s_cmp_eq_u32 s58, 2
    s_cbranch_scc1 L_i168
    s_waitcnt vmcnt(4)
    s_cbranch_vccz L_i168
    s_waitcnt vmcnt(4)
L_i168:
    buffer_load_dwordx4 v[208:211], v1, s[32:35], s53 offen offset:0 nt
    s_waitcnt lgkmcnt(0)
    v_readfirstlane_b32 s58, v75
    v_cmp_eq_u32 vcc, 0, v75
    v_mfma_f32_16x16x32_bf16 v[24:27], v[36:39], v[176:179], v[24:27]
    s_waitcnt vmcnt(7)
    s_waitcnt vmcnt(6)
    s_cmp_eq_u32 s58, 2
    s_cbranch_scc1 L_i169
    s_waitcnt vmcnt(5)
    s_cbranch_vccz L_i169
    s_waitcnt vmcnt(4)
L_i169:
    buffer_load_dwordx4 v[212:215], v1, s[32:35], s53 offen offset:128 nt
    v_mfma_f32_16x16x32_bf16 v[28:31], v[36:39], v[180:183], v[28:31]
    s_waitcnt vmcnt(7)
    s_waitcnt vmcnt(6)
    s_cmp_eq_u32 s58, 2
    s_cbranch_scc1 L_i170
    s_waitcnt vmcnt(4)
    s_cbranch_vccz L_i170
    s_waitcnt vmcnt(4)
L_i170:
    buffer_load_dwordx4 v[216:219], v1, s[32:35], s53 offen offset:256 nt
    s_add_u32 s53, s59, 800
    s_and_b32 s53, s53, 1023
    s_mul_i32 s53, s53, 3072
    s_add_u32 s53, s53, s60
    v_mov_b32 v2, 162
    ds_read_b32 v75, v0 offset:8720
    ds_write_b32 v0, v2 offset:8704
    v_mfma_f32_16x16x32_bf16 v[20:23], v[32:35], v[184:187], v[20:23]
    v_cvt_pk_bf16_f32 v63, v63, v63
    v_and_b32 v36, v4, v63
    v_and_b32 v37, v5, v63
    v_and_b32 v38, v6, v63
    v_and_b32 v39, v7, v63
    s_waitcnt vmcnt(7)
    s_waitcnt vmcnt(6)
    s_cmp_eq_u32 s58, 2
    s_cbranch_scc1 L_i171
    s_waitcnt vmcnt(5)
    s_cbranch_vccz L_i171
    s_waitcnt vmcnt(4)
L_i171:
    buffer_load_dwordx4 v[220:223], v1, s[32:35], s53 offen offset:0 nt
    s_waitcnt lgkmcnt(0)
    v_readfirstlane_b32 s58, v75
    v_cmp_eq_u32 vcc, 0, v75
    v_mfma_f32_16x16x32_bf16 v[24:27], v[32:35], v[188:191], v[24:27]
    s_waitcnt vmcnt(7)
    s_waitcnt vmcnt(6)
    s_cmp_eq_u32 s58, 2
    s_cbranch_scc1 L_i172
    s_waitcnt vmcnt(4)
    s_cbranch_vccz L_i172
    s_waitcnt vmcnt(4)
L_i172:
    buffer_load_dwordx4 v[224:227], v1, s[32:35], s53 offen offset:128 nt
    v_mfma_f32_16x16x32_bf16 v[28:31], v[32:35], v[192:195], v[28:31]
    s_waitcnt vmcnt(7)
    s_waitcnt vmcnt(6)
    s_cmp_eq_u32 s58, 2
    s_cbranch_scc1 L_i173
    s_waitcnt vmcnt(5)
    s_cbranch_vccz L_i173
    s_waitcnt vmcnt(4)
L_i173:
    buffer_load_dwordx4 v[228:231], v1, s[32:35], s53 offen offset:256 nt
    s_add_u32 s53, s59, 832
    s_and_b32 s53, s53, 1023
    s_mul_i32 s53, s53, 3072
    s_add_u32 s53, s53, s60
    v_mov_b32 v2, 165
    ds_read_b32 v75, v0 offset:8720
    ds_write_b32 v0, v2 offset:8704
    v_mfma_f32_16x16x32_bf16 v[20:23], v[36:39], v[196:199], v[20:23]
    v_cvt_pk_bf16_f32 v64, v64, v64
    v_and_b32 v32, v4, v64
    v_and_b32 v33, v5, v64
    v_and_b32 v34, v6, v64
    v_and_b32 v35, v7, v64
    s_waitcnt vmcnt(7)
    s_waitcnt vmcnt(6)
    s_cmp_eq_u32 s58, 2
    s_cbranch_scc1 L_i174
    s_waitcnt vmcnt(4)
    s_cbranch_vccz L_i174
    s_waitcnt vmcnt(4)
L_i174:
    buffer_load_dwordx4 v[232:235], v1, s[32:35], s53 offen offset:0 nt
    s_waitcnt lgkmcnt(0)
    v_readfirstlane_b32 s58, v75
    v_cmp_eq_u32 vcc, 0, v75
    v_mfma_f32_16x16x32_bf16 v[24:27], v[36:39], v[200:203], v[24:27]
    s_waitcnt vmcnt(7)
    s_waitcnt vmcnt(6)
    s_cmp_eq_u32 s58, 2
    s_cbranch_scc1 L_i175
    s_waitcnt vmcnt(5)
    s_cbranch_vccz L_i175
    s_waitcnt vmcnt(4)
L_i175:
    buffer_load_dwordx4 v[236:239], v1, s[32:35], s53 offen offset:128 nt
    v_mfma_f32_16x16x32_bf16 v[28:31], v[36:39], v[204:207], v[28:31]
    s_waitcnt vmcnt(7)
    s_waitcnt vmcnt(6)
    s_cmp_eq_u32 s58, 2
    s_cbranch_scc1 L_i176
    s_waitcnt vmcnt(4)
    s_cbranch_vccz L_i176
    s_waitcnt vmcnt(4)
L_i176:
    buffer_load_dwordx4 v[240:243], v1, s[32:35], s53 offen offset:256 nt
    s_add_u32 s53, s59, 864
    s_and_b32 s53, s53, 1023
    s_mul_i32 s53, s53, 3072
    s_add_u32 s53, s53, s60
    v_mov_b32 v2, 168
    ds_read_b32 v75, v0 offset:8720
    ds_write_b32 v0, v2 offset:8704
    v_mfma_f32_16x16x32_bf16 v[20:23], v[32:35], v[208:211], v[20:23]
    v_cvt_pk_bf16_f32 v65, v65, v65
    v_and_b32 v36, v4, v65
    v_and_b32 v37, v5, v65
    v_and_b32 v38, v6, v65
    v_and_b32 v39, v7, v65
    s_waitcnt vmcnt(7)
    s_waitcnt vmcnt(6)
    s_cmp_eq_u32 s58, 2
    s_cbranch_scc1 L_i177
    s_waitcnt vmcnt(5)
    s_cbranch_vccz L_i177
    s_waitcnt vmcnt(4)
L_i177:
    buffer_load_dwordx4 v[244:247], v1, s[32:35], s53 offen offset:0 nt
    s_waitcnt lgkmcnt(0)
    v_readfirstlane_b32 s58, v75
    v_cmp_eq_u32 vcc, 0, v75
    v_mfma_f32_16x16x32_bf16 v[24:27], v[32:35], v[212:215], v[24:27]
    s_waitcnt vmcnt(7)
    s_waitcnt vmcnt(6)
    s_cmp_eq_u32 s58, 2
    s_cbranch_scc1 L_i178
    s_waitcnt vmcnt(4)
    s_cbranch_vccz L_i178
    s_waitcnt vmcnt(4)
L_i178:
    buffer_load_dwordx4 v[248:251], v1, s[32:35], s53 offen offset:128 nt
    v_mfma_f32_16x16x32_bf16 v[28:31], v[32:35], v[216:219], v[28:31]
    s_waitcnt vmcnt(7)
    s_waitcnt vmcnt(6)
    s_cmp_eq_u32 s58, 2
    s_cbranch_scc1 L_i179
    s_waitcnt vmcnt(5)
    s_cbranch_vccz L_i179
    s_waitcnt vmcnt(4)
L_i179:
    buffer_load_dwordx4 v[252:255], v1, s[32:35], s53 offen offset:256 nt
    s_add_u32 s53, s59, 896
    s_and_b32 s53, s53, 1023
    s_mul_i32 s53, s53, 3072
    s_add_u32 s53, s53, s60
    v_mov_b32 v2, 171
    ds_read_b32 v75, v0 offset:8720
    ds_write_b32 v0, v2 offset:8704
    v_mfma_f32_16x16x32_bf16 v[20:23], v[36:39], v[220:223], v[20:23]
    v_cvt_pk_bf16_f32 v66, v66, v66
    v_and_b32 v32, v4, v66
    v_and_b32 v33, v5, v66
    v_and_b32 v34, v6, v66
    v_and_b32 v35, v7, v66
    s_waitcnt vmcnt(7)
    s_waitcnt vmcnt(6)
    s_cmp_eq_u32 s58, 2
    s_cbranch_scc1 L_i180
    s_waitcnt vmcnt(4)
    s_cbranch_vccz L_i180
    s_waitcnt vmcnt(4)
L_i180:
    buffer_load_dwordx4 v[76:79], v1, s[32:35], s53 offen offset:0 nt
    s_waitcnt lgkmcnt(0)
    v_readfirstlane_b32 s58, v75
    v_cmp_eq_u32 vcc, 0, v75
    v_mfma_f32_16x16x32_bf16 v[24:27], v[36:39], v[224:227], v[24:27]
    s_waitcnt vmcnt(7)
    s_waitcnt vmcnt(6)
    s_cmp_eq_u32 s58, 2
    s_cbranch_scc1 L_i181
    s_waitcnt vmcnt(5)
    s_cbranch_vccz L_i181
    s_waitcnt vmcnt(4)
L_i181:
    buffer_load_dwordx4 v[80:83], v1, s[32:35], s53 offen offset:128 nt
    v_mfma_f32_16x16x32_bf16 v[28:31], v[36:39], v[228:231], v[28:31]
    s_waitcnt vmcnt(7)
    s_waitcnt vmcnt(6)
    s_cmp_eq_u32 s58, 2
    s_cbranch_scc1 L_i182
    s_waitcnt vmcnt(4)
    s_cbranch_vccz L_i182
    s_waitcnt vmcnt(4)
L_i182:
    buffer_load_dwordx4 v[84:87], v1, s[32:35], s53 offen offset:256 nt
    s_add_u32 s53, s59, 928
    s_and_b32 s53, s53, 1023
    s_mul_i32 s53, s53, 3072
    s_add_u32 s53, s53, s60
    v_mov_b32 v2, 174
    ds_read_b32 v75, v0 offset:8720
    ds_write_b32 v0, v2 offset:8704
    v_mfma_f32_16x16x32_bf16 v[20:23], v[32:35], v[232:235], v[20:23]
    v_cvt_pk_bf16_f32 v67, v67, v67
    v_and_b32 v36, v4, v67
    v_and_b32 v37, v5, v67
    v_and_b32 v38, v6, v67
    v_and_b32 v39, v7, v67
    s_waitcnt vmcnt(7)
    s_waitcnt vmcnt(6)
    s_cmp_eq_u32 s58, 2
    s_cbranch_scc1 L_i183
    s_waitcnt vmcnt(5)
    s_cbranch_vccz L_i183
    s_waitcnt vmcnt(4)
L_i183:
    buffer_load_dwordx4 v[88:91], v1, s[32:35], s53 offen offset:0 nt
    s_waitcnt lgkmcnt(0)
    v_readfirstlane_b32 s58, v75
    v_cmp_eq_u32 vcc, 0, v75
    v_mfma_f32_16x16x32_bf16 v[24:27], v[32:35], v[236:239], v[24:27]
    s_waitcnt vmcnt(7)
    s_waitcnt vmcnt(6)
    s_cmp_eq_u32 s58, 2
    s_cbranch_scc1 L_i184
    s_waitcnt vmcnt(4)
    s_cbranch_vccz L_i184
    s_waitcnt vmcnt(4)
L_i184:
    buffer_load_dwordx4 v[92:95], v1, s[32:35], s53 offen offset:128 nt
    v_mfma_f32_16x16x32_bf16 v[28:31], v[32:35], v[240:243], v[28:31]
    s_waitcnt vmcnt(7)
    s_waitcnt vmcnt(6)
    s_cmp_eq_u32 s58, 2
    s_cbranch_scc1 L_i185
    s_waitcnt vmcnt(5)
    s_cbranch_vccz L_i185
    s_waitcnt vmcnt(4)
L_i185:
    buffer_load_dwordx4 v[96:99], v1, s[32:35], s53 offen offset:256 nt
    s_add_u32 s53, s59, 960
    s_and_b32 s53, s53, 1023
    s_mul_i32 s53, s53, 3072
    s_add_u32 s53, s53, s60
    v_mov_b32 v2, 177
    ds_read_b32 v75, v0 offset:8720
    ds_write_b32 v0, v2 offset:8704
    v_mfma_f32_16x16x32_bf16 v[20:23], v[36:39], v[244:247], v[20:23]
    v_cvt_pk_bf16_f32 v68, v68, v68
    v_and_b32 v32, v4, v68
    v_and_b32 v33, v5, v68
    v_and_b32 v34, v6, v68
    v_and_b32 v35, v7, v68
    s_waitcnt vmcnt(7)
    s_waitcnt vmcnt(6)
    s_cmp_eq_u32 s58, 2
    s_cbranch_scc1 L_i186
    s_waitcnt vmcnt(4)
    s_cbranch_vccz L_i186
    s_waitcnt vmcnt(4)
L_i186:
    buffer_load_dwordx4 v[100:103], v1, s[32:35], s53 offen offset:0 nt
    s_waitcnt lgkmcnt(0)
    v_readfirstlane_b32 s58, v75
    v_cmp_eq_u32 vcc, 0, v75
    v_mfma_f32_16x16x32_bf16 v[24:27], v[36:39], v[248:251], v[24:27]
    s_waitcnt vmcnt(7)
    s_waitcnt vmcnt(6)
    s_cmp_eq_u32 s58, 2
    s_cbranch_scc1 L_i187
    s_waitcnt vmcnt(5)
    s_cbranch_vccz L_i187
    s_waitcnt vmcnt(4)
L_i187:
    buffer_load_dwordx4 v[104:107], v1, s[32:35], s53 offen offset:128 nt
    v_mfma_f32_16x16x32_bf16 v[28:31], v[36:39], v[252:255], v[28:31]
    s_waitcnt vmcnt(7)
    s_waitcnt vmcnt(6)
    s_cmp_eq_u32 s58, 2
    s_cbranch_scc1 L_i188
    s_waitcnt vmcnt(4)
    s_cbranch_vccz L_i188
    s_waitcnt vmcnt(4)
L_i188:
    buffer_load_dwordx4 v[108:111], v1, s[32:35], s53 offen offset:256 nt
    s_add_u32 s53, s59, 992
    s_and_b32 s53, s53, 1023
    s_mul_i32 s53, s53, 3072
    s_add_u32 s53, s53, s60
    v_mov_b32 v2, 180
    ds_read_b32 v75, v0 offset:8720
    ds_write_b32 v0, v2 offset:8704
    v_mfma_f32_16x16x32_bf16 v[20:23], v[32:35], v[76:79], v[20:23]
    v_cvt_pk_bf16_f32 v69, v69, v69
    v_and_b32 v36, v4, v69
    v_and_b32 v37, v5, v69
    v_and_b32 v38, v6, v69
    v_and_b32 v39, v7, v69
    s_waitcnt vmcnt(7)
    s_waitcnt vmcnt(6)
    s_cmp_eq_u32 s58, 2
    s_cbranch_scc1 L_i189
    s_waitcnt vmcnt(5)
    s_cbranch_vccz L_i189
    s_waitcnt vmcnt(4)
L_i189:
    buffer_load_dwordx4 v[112:115], v1, s[32:35], s53 offen offset:0 nt
    s_waitcnt lgkmcnt(0)
    v_readfirstlane_b32 s58, v75
    v_cmp_eq_u32 vcc, 0, v75
    v_mfma_f32_16x16x32_bf16 v[24:27], v[32:35], v[80:83], v[24:27]
    s_waitcnt vmcnt(7)
    s_waitcnt vmcnt(6)
    s_cmp_eq_u32 s58, 2
    s_cbranch_scc1 L_i190
    s_waitcnt vmcnt(4)
    s_cbranch_vccz L_i190
    s_waitcnt vmcnt(4)
L_i190:
    buffer_load_dwordx4 v[116:119], v1, s[32:35], s53 offen offset:128 nt
    v_mfma_f32_16x16x32_bf16 v[28:31], v[32:35], v[84:87], v[28:31]
    s_waitcnt vmcnt(7)
    s_waitcnt vmcnt(6)
    s_cmp_eq_u32 s58, 2
    s_cbranch_scc1 L_i191
    s_waitcnt vmcnt(5)
    s_cbranch_vccz L_i191
    s_waitcnt vmcnt(4)
L_i191:
    buffer_load_dwordx4 v[120:123], v1, s[32:35], s53 offen offset:256 nt
    s_add_u32 s53, s59, 0
    s_and_b32 s53, s53, 1023
    s_mul_i32 s53, s53, 3072
    s_add_u32 s53, s53, s60
    s_barrier
    v_mov_b32 v0, 0
    ds_read_b128 v[8:11], v0 offset:8768
    ds_read_b32 v73, v0 offset:8784
    v_mbcnt_lo_u32_b32 v2, -1, 0
    v_mbcnt_hi_u32_b32 v2, -1, v2
    s_add_u32 s87, s87, 0x07050301
    s_movk_i32 s92, 0xff
    v_and_b32 v72, 3, v2
    v_lshlrev_b32 v72, 3, v72
    v_lshrrev_b32 v72, v72, s87
    v_lshlrev_b32 v2, 2, v2
    v_lshl_add_u32 v2, s3, 8, v2
    s_lshl_b32 s15, s6, 3
    s_add_u32 s15, s15, s7
    s_mul_i32 s15, s15, 768
    s_add_u32 s15, s15, 8192
    v_mfma_f32_16x16x32_bf16 v[20:23], v[36:39], v[88:91], v[20:23]
    v_cvt_pk_bf16_f32 v70, v70, v70
    v_and_b32 v32, v4, v70
    v_and_b32 v33, v5, v70
    v_and_b32 v34, v6, v70
    v_and_b32 v35, v7, v70
    s_waitcnt vmcnt(7)
    v_mfma_f32_16x16x32_bf16 v[24:27], v[36:39], v[92:95], v[24:27]
    s_waitcnt vmcnt(6)
    v_mfma_f32_16x16x32_bf16 v[28:31], v[36:39], v[96:99], v[28:31]
    s_waitcnt vmcnt(5)
    v_mfma_f32_16x16x32_bf16 v[20:23], v[32:35], v[100:103], v[20:23]
    v_cvt_pk_bf16_f32 v71, v71, v71
    v_and_b32 v36, v4, v71
    v_and_b32 v37, v5, v71
    v_and_b32 v38, v6, v71
    v_and_b32 v39, v7, v71
    s_waitcnt vmcnt(4)
    v_mfma_f32_16x16x32_bf16 v[24:27], v[32:35], v[104:107], v[24:27]
    s_waitcnt vmcnt(3)
    v_mfma_f32_16x16x32_bf16 v[28:31], v[32:35], v[108:111], v[28:31]
    s_waitcnt vmcnt(2)
    v_mfma_f32_16x16x32_bf16 v[20:23], v[36:39], v[112:115], v[20:23]
    s_waitcnt vmcnt(1)
    v_mfma_f32_16x16x32_bf16 v[24:27], v[36:39], v[116:119], v[24:27]
    s_waitcnt vmcnt(0)
    v_mfma_f32_16x16x32_bf16 v[28:31], v[36:39], v[120:123], v[28:31]
    s_mov_b32 exec_lo, 0x00ff00ff
    s_mov_b32 exec_hi, 0xff00ff00
    s_nop 1
    ds_write_b128 v3, v[20:23] offset:0
    s_nop 0
    ds_write_b128 v3, v[24:27] offset:256
    s_nop 0
    ds_write_b128 v3, v[28:31] offset:512
    s_waitcnt lgkmcnt(0)
    s_mov_b64 exec, -1
    s_cmp_eq_u32 s3, 3
    s_barrier
    s_cbranch_scc1 L_end
    ds_read2st64_b32 v[12:13], v2 offset0:0 offset1:3
    ds_read2st64_b32 v[14:15], v2 offset0:6 offset1:9
    ds_read2st64_b32 v[16:17], v2 offset0:12 offset1:15
    ds_read2st64_b32 v[18:19], v2 offset0:18 offset1:21
    s_waitcnt lgkmcnt(3)
    v_add_f32 v12, v12, v13
    v_mul_f32 v12, v8, v12
    s_waitcnt lgkmcnt(2)
    v_add_f32 v14, v14, v15
    v_fmac_f32 v12, v9, v14
    s_waitcnt lgkmcnt(1)
    v_add_f32 v16, v16, v17
    v_fmac_f32 v12, v10, v16
    s_waitcnt lgkmcnt(0)
    v_add_f32 v18, v18, v19
    v_fmac_f32 v12, v11, v18
    v_bfi_b32 v12, s92, v72, v12
    buffer_store_dword v12, v2, s[24:27], s15 offen
    s_add_u32 s15, s15, 385024
    v_readfirstlane_b32 s9, v73
    s_cmp_eq_u32 s9, 1
    s_cbranch_scc1 L_ou
    buffer_store_dword v12, v2, s[24:27], s15 offen sc1
L_ou:
    s_cmp_ge_u32 s5, 30
    s_cbranch_scc1 L_end
    s_barrier
    s_barrier
L_end:
    s_endpgm
.section .rodata,"a"
.p2align 6
.amdhsa_kernel parallel_sum__gqa_block_cached__glu_gated_geglu__decode_kernel
.amdhsa_next_free_vgpr 256
.amdhsa_next_free_sgpr 96
.amdhsa_accum_offset 256
.amdhsa_group_segment_fixed_size 0
.amdhsa_kernarg_size 96
.amdhsa_user_sgpr_count 2
.amdhsa_user_sgpr_kernarg_segment_ptr 1
.amdhsa_system_sgpr_workgroup_id_x 1
.amdhsa_float_denorm_mode_32 3
.end_amdhsa_kernel
```
